```python
import torch

def _softmax(x, axis=-1):
    return torch.softmax(x, dim=axis)
def _gelu(x):
    return torch.nn.functional.gelu(x, approximate="tanh")
def _silu(x):
    return torch.nn.functional.silu(x)
def _sigmoid(x):
    return torch.sigmoid(x)
def _layernorm(x, axis=-1, eps=1e-5):
    m = x.mean(dim=axis, keepdim=True)
    v = x.var(dim=axis, keepdim=True, unbiased=False)
    return (x - m) / torch.sqrt(v + eps)
def _scatter_add(tgt, idx, src, axis=0):
    return tgt.clone().index_add_(axis, idx, src)
def _segment_sum(src, seg, n):
    out = torch.zeros((n,) + src.shape[1:], dtype=src.dtype)
    return out.index_add_(0, seg, src)
def _pad(x, pw):
    flat = tuple(v for pair in reversed(pw) for v in pair)
    return torch.nn.functional.pad(x, flat)

kernel_name = 'gated_mix__spectral_gfnet__mixer_token_mlp__prompt'

def setup_inputs():

    _w = (lambda a: (lambda t: t.to(torch.bfloat16) if t.is_floating_point() else t)(torch.as_tensor(a)))
    def _A_setup():
        B, S, D = 1, 2048, 512
        Df = D // 2 + 1
        return {
            "x": _w((lambda *s: torch.randn(*s, dtype=torch.bfloat16) * 0.05)(B, S, D)),
            "w_r": _w((lambda *s: torch.randn(*s, dtype=torch.bfloat16) * 0.8)(S, Df) * 0.02),
            "w_i": _w((lambda *s: torch.randn(*s, dtype=torch.bfloat16) * 1.6)(S, Df) * 0.02),
        }
    _A_in = _A_setup()

    def _B_setup():
        B, S, D, F = 1, 2048, 512, 1792
        return {
            "x": _w((lambda *s: torch.randn(*s, dtype=torch.bfloat16) * 0.05)(B, S, D)),
            "w1": _w((lambda *s: torch.randn(*s, dtype=torch.bfloat16) * 0.2)(S, F) * (S ** -0.5)),
            "b1": _w((lambda *s: torch.randn(*s, dtype=torch.bfloat16) * 3.2)(F) * 0.02),
            "w2": _w((lambda *s: torch.randn(*s, dtype=torch.bfloat16) * 0.05)(F, S) * (F ** -0.5)),
            "b2": _w((lambda *s: torch.randn(*s, dtype=torch.bfloat16) * 0.1)(S) * 0.02),
        }
    _B_in = _B_setup()

    return {
        "A_x": _A_in["x"],
        "A_w_r": _A_in["w_r"],
        "A_w_i": _A_in["w_i"],
        "B_x": _B_in["x"],
        "B_w1": _B_in["w1"],
        "B_b1": _B_in["b1"],
        "B_w2": _B_in["w2"],
        "B_b2": _B_in["b2"],
        "gate_w": _w((lambda *s: torch.randn(*s, dtype=torch.bfloat16) * 0.05)(512) * 16.0),
    }

def reference(A_x, A_w_r, A_w_i, B_x, B_w1, B_b1, B_w2, B_b2, gate_w):
    def _A_ref(x, w_r, w_i):
        B, S, D = x.shape
        X = (lambda x, axes=(-2,-1): torch.fft.rfft2(x.float(), dim=axes))(x, axes=(-2, -1))
        W = w_r + 1j * w_i
        X = X * W
        y = (lambda x, s, axes=(-2,-1): torch.fft.irfft2(x, s=s, dim=axes).to(torch.bfloat16))(X, (S, D), axes=(-2, -1))
        return y

    def _B_ref(x, w1, b1, w2, b2):
        B, S, D = x.shape
        h = _layernorm(x, axis=-1)
        u = torch.einsum("bsd,sf->bdf", h, w1) + b1
        u = _gelu(u)
        y = torch.einsum("bdf,fs->bds", u, w2) + b2
        return (lambda x, *d: x.permute(*d))(y, 0, 2, 1)

    x = A_x
    g = _sigmoid((x * gate_w).sum(-1, keepdims=True))
    a = _A_ref(x, A_w_r, A_w_i)
    b = _B_ref(x, B_w1, B_b1, B_w2, B_b2)
    return g * a + (1 - g) * b
```

```asm
; @launch grid=(256,1,1) block=(512,1,1) lds=155904
.amdgcn_target "amdgcn-amd-amdhsa--gfx950"
.text
.globl gated_mix__spectral_gfnet__mixer_token_mlp__prompt_kernel
.p2align 8
.type gated_mix__spectral_gfnet__mixer_token_mlp__prompt_kernel,@function
gated_mix__spectral_gfnet__mixer_token_mlp__prompt_kernel:
    s_load_dwordx16 s[48:63], s[0:1], 0
    s_load_dwordx8 s[64:71], s[0:1], 64
    v_lshrrev_b32 v1, 6, v0
    v_and_b32 v2, 63, v0
    v_readfirstlane_b32 s3, v1
    s_cmp_ge_u32 s2, 256
    s_cbranch_scc1 k_end
    s_and_b32 s22, s2, 7
    s_lshr_b32 s23, s2, 3
    v_lshlrev_b32 v5, 4, v2
    v_mov_b32 v8, 155648
    v_mov_b32 v9, 1
    v_mov_b32 v12, v5
    s_lshl_b32 s24, s2, 2
    v_lshlrev_b32 v11, 12, v2
    v_add_u32 v11, s24, v11
    s_lshr_b32 s4, s3, 2
    s_and_b32 s3, s3, 3
    v_lshl_add_u32 v10, v2, 2, v8
    v_mov_b32 v1, 0
    ds_write_b32 v10, v1
    v_mov_b32 v1, 0x40000000
    s_cmp_eq_u32 s4, 0
    s_cbranch_scc1 g_start
f_start:
    s_and_b32 s24, s23, 3
    s_lshr_b32 s25, s23, 2
    s_lshl_b32 s26, s22, 8
    s_lshl_b32 s27, s24, 3
    s_add_u32 s26, s26, s27
    s_add_u32 s26, s26, s3
    s_lshl_b32 s26, s26, 10
    s_lshl_b32 s27, s3, 12
    s_lshl_b32 s28, s3, 6
    v_xor_b32 v3, s28, v5
    v_xor_b32 v24, 0, v3
    v_xor_b32 v25, 16, v3
    v_add_u32 v25, 31744, v25
    v_xor_b32 v26, 32, v3
    v_add_u32 v26, 63488, v26
    v_xor_b32 v27, 48, v3
    v_add_u32 v27, 95232, v27
    s_waitcnt lgkmcnt(0)
    s_mov_b32 s8, s48
    s_and_b32 s9, s49, 0xffff
    s_mov_b32 s10, 2097152
    s_mov_b32 s11, 0x20000
    s_add_u32 m0, s27, 16384
    s_add_u32 s29, s26, 0
    buffer_load_dwordx4 v24, s[8:11], s29 offen offset:0 lds
    buffer_load_dwordx4 v25, s[8:11], s29 offen offset:1024 lds
    buffer_load_dwordx4 v26, s[8:11], s29 offen offset:2048 lds
    buffer_load_dwordx4 v27, s[8:11], s29 offen offset:3072 lds
    s_add_u32 m0, s27, 49152
    s_add_u32 s29, s26, 131072
    buffer_load_dwordx4 v24, s[8:11], s29 offen offset:0 lds
    buffer_load_dwordx4 v25, s[8:11], s29 offen offset:1024 lds
    buffer_load_dwordx4 v26, s[8:11], s29 offen offset:2048 lds
    buffer_load_dwordx4 v27, s[8:11], s29 offen offset:3072 lds
    s_add_u32 m0, s27, 81920
    s_add_u32 s29, s26, 4096
    buffer_load_dwordx4 v24, s[8:11], s29 offen offset:0 lds
    buffer_load_dwordx4 v25, s[8:11], s29 offen offset:1024 lds
    buffer_load_dwordx4 v26, s[8:11], s29 offen offset:2048 lds
    buffer_load_dwordx4 v27, s[8:11], s29 offen offset:3072 lds
    s_add_u32 m0, s27, 114688
    s_add_u32 s29, s26, 135168
    buffer_load_dwordx4 v24, s[8:11], s29 offen offset:0 lds
    buffer_load_dwordx4 v25, s[8:11], s29 offen offset:1024 lds
    buffer_load_dwordx4 v26, s[8:11], s29 offen offset:2048 lds
    buffer_load_dwordx4 v27, s[8:11], s29 offen offset:3072 lds
    s_mov_b32 s12, s70
    s_and_b32 s13, s71, 0xffff
    s_mov_b32 s14, 20971520
    s_mov_b32 s15, 0x20000
    s_barrier
    v_and_b32 v13, 15, v2
    v_lshrrev_b32 v14, 4, v2
    v_and_b32 v15, 7, v2
    s_lshl_b32 s30, s25, 5
    s_lshl_b32 s31, s3, 3
    s_add_u32 s30, s30, s31
    v_add_u32 v15, s30, v15
    v_lshrrev_b32 v20, 3, v13
    v_cvt_f32_u32 v16, v15
    v_mul_f32 v16, 0x3b000000, v16
    v_cvt_f32_u32 v17, v20
    v_mul_f32 v17, 0x3e800000, v17
    v_mov_b32 v19, 1.0
    v_cmp_eq_u32 vcc, 0, v15
    s_nop 1
    v_cndmask_b32 v19, v19, 0.5, vcc
    v_lshlrev_b32 v21, 1, v15
    v_or_b32 v21, v21, v20
    v_cmp_eq_u32 vcc, 1, v21
    s_nop 1
    v_cndmask_b32 v16, v16, 0.5, vcc
    v_cndmask_b32 v17, v17, 0, vcc
    v_lshlrev_b32 v21, 3, v14
    v_cvt_f32_u32 v21, v21
    v_fma_f32 v17, v16, v21, v17
    v_mul_f32 v18, 0x42000000, v16
    v_cos_f32 v18, v18
    s_nop 0
    v_add_f32 v18, v18, v18
    v_mov_b32 v96, v17
    v_fma_f32 v97, v16, 1.0, v17
    v_fma_f32 v98, v16, 2.0, v17
    v_fmamk_f32 v99, v16, 0x40400000, v17
    v_fma_f32 v100, v16, 4.0, v17
    v_fmamk_f32 v101, v16, 0x40a00000, v17
    v_fmamk_f32 v102, v16, 0x40c00000, v17
    v_fmamk_f32 v103, v16, 0x40e00000, v17
    v_cos_f32 v96, v96
    v_cos_f32 v97, v97
    v_cos_f32 v98, v98
    v_cos_f32 v99, v99
    v_cos_f32 v100, v100
    v_cos_f32 v101, v101
    v_cos_f32 v102, v102
    v_cos_f32 v103, v103
    v_mul_f32 v96, v19, v96
    v_mul_f32 v97, v19, v97
    v_mul_f32 v98, v19, v98
    v_mul_f32 v99, v19, v99
    v_mul_f32 v100, v19, v100
    v_mul_f32 v101, v19, v101
    v_mul_f32 v102, v19, v102
    v_mul_f32 v103, v19, v103
    v_cvt_pk_bf16_f32 v32, v96, v97
    v_cvt_pk_bf16_f32 v33, v98, v99
    v_cvt_pk_bf16_f32 v34, v100, v101
    v_cvt_pk_bf16_f32 v35, v102, v103
    v_fmamk_f32 v104, v16, 0x42000000, v17
    v_fmamk_f32 v105, v16, 0x42040000, v17
    v_fmamk_f32 v106, v16, 0x42080000, v17
    v_fmamk_f32 v107, v16, 0x420c0000, v17
    v_fmamk_f32 v108, v16, 0x42100000, v17
    v_fmamk_f32 v109, v16, 0x42140000, v17
    v_fmamk_f32 v110, v16, 0x42180000, v17
    v_fmamk_f32 v111, v16, 0x421c0000, v17
    v_cos_f32 v104, v104
    v_cos_f32 v105, v105
    v_cos_f32 v106, v106
    v_cos_f32 v107, v107
    v_cos_f32 v108, v108
    v_cos_f32 v109, v109
    v_cos_f32 v110, v110
    v_cos_f32 v111, v111
    v_mul_f32 v104, v19, v104
    v_mul_f32 v105, v19, v105
    v_mul_f32 v106, v19, v106
    v_mul_f32 v107, v19, v107
    v_mul_f32 v108, v19, v108
    v_mul_f32 v109, v19, v109
    v_mul_f32 v110, v19, v110
    v_mul_f32 v111, v19, v111
    v_cvt_pk_bf16_f32 v36, v104, v105
    v_cvt_pk_bf16_f32 v37, v106, v107
    v_cvt_pk_bf16_f32 v38, v108, v109
    v_cvt_pk_bf16_f32 v39, v110, v111
    v_fma_f32 v96, v18, v104, -v96
    v_fma_f32 v97, v18, v105, -v97
    v_fma_f32 v98, v18, v106, -v98
    v_fma_f32 v99, v18, v107, -v99
    v_fma_f32 v100, v18, v108, -v100
    v_fma_f32 v101, v18, v109, -v101
    v_fma_f32 v102, v18, v110, -v102
    v_fma_f32 v103, v18, v111, -v103
    v_cvt_pk_bf16_f32 v40, v96, v97
    v_cvt_pk_bf16_f32 v41, v98, v99
    v_cvt_pk_bf16_f32 v42, v100, v101
    v_cvt_pk_bf16_f32 v43, v102, v103
    v_fma_f32 v104, v18, v96, -v104
    v_fma_f32 v105, v18, v97, -v105
    v_fma_f32 v106, v18, v98, -v106
    v_fma_f32 v107, v18, v99, -v107
    v_fma_f32 v108, v18, v100, -v108
    v_fma_f32 v109, v18, v101, -v109
    v_fma_f32 v110, v18, v102, -v110
    v_fma_f32 v111, v18, v103, -v111
    v_cvt_pk_bf16_f32 v44, v104, v105
    v_cvt_pk_bf16_f32 v45, v106, v107
    v_cvt_pk_bf16_f32 v46, v108, v109
    v_cvt_pk_bf16_f32 v47, v110, v111
    v_fma_f32 v96, v18, v104, -v96
    v_fma_f32 v97, v18, v105, -v97
    v_fma_f32 v98, v18, v106, -v98
    v_fma_f32 v99, v18, v107, -v99
    v_fma_f32 v100, v18, v108, -v100
    v_fma_f32 v101, v18, v109, -v101
    v_fma_f32 v102, v18, v110, -v102
    v_fma_f32 v103, v18, v111, -v103
    v_cvt_pk_bf16_f32 v48, v96, v97
    v_cvt_pk_bf16_f32 v49, v98, v99
    v_cvt_pk_bf16_f32 v50, v100, v101
    v_cvt_pk_bf16_f32 v51, v102, v103
    v_fma_f32 v104, v18, v96, -v104
    v_fma_f32 v105, v18, v97, -v105
    v_fma_f32 v106, v18, v98, -v106
    v_fma_f32 v107, v18, v99, -v107
    v_fma_f32 v108, v18, v100, -v108
    v_fma_f32 v109, v18, v101, -v109
    v_fma_f32 v110, v18, v102, -v110
    v_fma_f32 v111, v18, v103, -v111
    v_cvt_pk_bf16_f32 v52, v104, v105
    v_cvt_pk_bf16_f32 v53, v106, v107
    v_cvt_pk_bf16_f32 v54, v108, v109
    v_cvt_pk_bf16_f32 v55, v110, v111
    v_fma_f32 v96, v18, v104, -v96
    v_fma_f32 v97, v18, v105, -v97
    v_fma_f32 v98, v18, v106, -v98
    v_fma_f32 v99, v18, v107, -v99
    v_fma_f32 v100, v18, v108, -v100
    v_fma_f32 v101, v18, v109, -v101
    v_fma_f32 v102, v18, v110, -v102
    v_fma_f32 v103, v18, v111, -v103
    v_cvt_pk_bf16_f32 v56, v96, v97
    v_cvt_pk_bf16_f32 v57, v98, v99
    v_cvt_pk_bf16_f32 v58, v100, v101
    v_cvt_pk_bf16_f32 v59, v102, v103
    v_fma_f32 v104, v18, v96, -v104
    v_fma_f32 v105, v18, v97, -v105
    v_fma_f32 v106, v18, v98, -v106
    v_fma_f32 v107, v18, v99, -v107
    v_fma_f32 v108, v18, v100, -v108
    v_fma_f32 v109, v18, v101, -v109
    v_fma_f32 v110, v18, v102, -v110
    v_fma_f32 v111, v18, v103, -v111
    v_cvt_pk_bf16_f32 v60, v104, v105
    v_cvt_pk_bf16_f32 v61, v106, v107
    v_cvt_pk_bf16_f32 v62, v108, v109
    v_cvt_pk_bf16_f32 v63, v110, v111
    v_fma_f32 v96, v18, v104, -v96
    v_fma_f32 v97, v18, v105, -v97
    v_fma_f32 v98, v18, v106, -v98
    v_fma_f32 v99, v18, v107, -v99
    v_fma_f32 v100, v18, v108, -v100
    v_fma_f32 v101, v18, v109, -v101
    v_fma_f32 v102, v18, v110, -v102
    v_fma_f32 v103, v18, v111, -v103
    v_cvt_pk_bf16_f32 v64, v96, v97
    v_cvt_pk_bf16_f32 v65, v98, v99
    v_cvt_pk_bf16_f32 v66, v100, v101
    v_cvt_pk_bf16_f32 v67, v102, v103
    v_fma_f32 v104, v18, v96, -v104
    v_fma_f32 v105, v18, v97, -v105
    v_fma_f32 v106, v18, v98, -v106
    v_fma_f32 v107, v18, v99, -v107
    v_fma_f32 v108, v18, v100, -v108
    v_fma_f32 v109, v18, v101, -v109
    v_fma_f32 v110, v18, v102, -v110
    v_fma_f32 v111, v18, v103, -v111
    v_cvt_pk_bf16_f32 v68, v104, v105
    v_cvt_pk_bf16_f32 v69, v106, v107
    v_cvt_pk_bf16_f32 v70, v108, v109
    v_cvt_pk_bf16_f32 v71, v110, v111
    v_fma_f32 v96, v18, v104, -v96
    v_fma_f32 v97, v18, v105, -v97
    v_fma_f32 v98, v18, v106, -v98
    v_fma_f32 v99, v18, v107, -v99
    v_fma_f32 v100, v18, v108, -v100
    v_fma_f32 v101, v18, v109, -v101
    v_fma_f32 v102, v18, v110, -v102
    v_fma_f32 v103, v18, v111, -v103
    v_cvt_pk_bf16_f32 v72, v96, v97
    v_cvt_pk_bf16_f32 v73, v98, v99
    v_cvt_pk_bf16_f32 v74, v100, v101
    v_cvt_pk_bf16_f32 v75, v102, v103
    v_fma_f32 v104, v18, v96, -v104
    v_fma_f32 v105, v18, v97, -v105
    v_fma_f32 v106, v18, v98, -v106
    v_fma_f32 v107, v18, v99, -v107
    v_fma_f32 v108, v18, v100, -v108
    v_fma_f32 v109, v18, v101, -v109
    v_fma_f32 v110, v18, v102, -v110
    v_fma_f32 v111, v18, v103, -v111
    v_cvt_pk_bf16_f32 v76, v104, v105
    v_cvt_pk_bf16_f32 v77, v106, v107
    v_cvt_pk_bf16_f32 v78, v108, v109
    v_cvt_pk_bf16_f32 v79, v110, v111
    v_fma_f32 v96, v18, v104, -v96
    v_fma_f32 v97, v18, v105, -v97
    v_fma_f32 v98, v18, v106, -v98
    v_fma_f32 v99, v18, v107, -v99
    v_fma_f32 v100, v18, v108, -v100
    v_fma_f32 v101, v18, v109, -v101
    v_fma_f32 v102, v18, v110, -v102
    v_fma_f32 v103, v18, v111, -v103
    v_cvt_pk_bf16_f32 v80, v96, v97
    v_cvt_pk_bf16_f32 v81, v98, v99
    v_cvt_pk_bf16_f32 v82, v100, v101
    v_cvt_pk_bf16_f32 v83, v102, v103
    v_fma_f32 v104, v18, v96, -v104
    v_fma_f32 v105, v18, v97, -v105
    v_fma_f32 v106, v18, v98, -v106
    v_fma_f32 v107, v18, v99, -v107
    v_fma_f32 v108, v18, v100, -v108
    v_fma_f32 v109, v18, v101, -v109
    v_fma_f32 v110, v18, v102, -v110
    v_fma_f32 v111, v18, v103, -v111
    v_cvt_pk_bf16_f32 v84, v104, v105
    v_cvt_pk_bf16_f32 v85, v106, v107
    v_cvt_pk_bf16_f32 v86, v108, v109
    v_cvt_pk_bf16_f32 v87, v110, v111
    v_fma_f32 v96, v18, v104, -v96
    v_fma_f32 v97, v18, v105, -v97
    v_fma_f32 v98, v18, v106, -v98
    v_fma_f32 v99, v18, v107, -v99
    v_fma_f32 v100, v18, v108, -v100
    v_fma_f32 v101, v18, v109, -v101
    v_fma_f32 v102, v18, v110, -v102
    v_fma_f32 v103, v18, v111, -v103
    v_cvt_pk_bf16_f32 v88, v96, v97
    v_cvt_pk_bf16_f32 v89, v98, v99
    v_cvt_pk_bf16_f32 v90, v100, v101
    v_cvt_pk_bf16_f32 v91, v102, v103
    v_fma_f32 v104, v18, v96, -v104
    v_fma_f32 v105, v18, v97, -v105
    v_fma_f32 v106, v18, v98, -v106
    v_fma_f32 v107, v18, v99, -v107
    v_fma_f32 v108, v18, v100, -v108
    v_fma_f32 v109, v18, v101, -v109
    v_fma_f32 v110, v18, v102, -v110
    v_fma_f32 v111, v18, v103, -v111
    v_cvt_pk_bf16_f32 v92, v104, v105
    v_cvt_pk_bf16_f32 v93, v106, v107
    v_cvt_pk_bf16_f32 v94, v108, v109
    v_cvt_pk_bf16_f32 v95, v110, v111
    v_lshlrev_b32 v21, 10, v13
    v_add_u32 v112, 0, v14
    v_xor_b32 v112, v112, v13
    v_lshl_add_u32 v112, v112, 4, v21
    v_add_u32 v116, 65536, v112
    v_add_u32 v113, 4, v14
    v_xor_b32 v113, v113, v13
    v_lshl_add_u32 v113, v113, 4, v21
    v_add_u32 v117, 65536, v113
    v_add_u32 v114, 8, v14
    v_xor_b32 v114, v114, v13
    v_lshl_add_u32 v114, v114, 4, v21
    v_add_u32 v118, 65536, v114
    v_add_u32 v115, 12, v14
    v_xor_b32 v115, v115, v13
    v_lshl_add_u32 v115, v115, 4, v21
    v_add_u32 v119, 65536, v115
    v_lshlrev_b32 v120, 13, v15
    v_lshl_add_u32 v120, v20, 6, v120
    v_lshl_add_u32 v120, v14, 4, v120
    s_lshr_b32 s30, s24, 1
    s_lshl_b32 s30, s30, 11
    s_lshl_b32 s31, s22, 8
    s_add_u32 s30, s30, s31
    s_and_b32 s31, s24, 1
    s_lshl_b32 s31, s31, 7
    s_add_u32 s30, s30, s31
    s_add_u32 s30, s30, 4194304
    s_add_u32 s31, s30, 4096
    v_cmp_lt_u32 s[32:33], 7, v13
    s_waitcnt vmcnt(0)
    s_mov_b64 exec, 1
    ds_add_u32 v8, v9 offset:0
    s_mov_b64 exec, -1
    s_mov_b32 s44, 524288
sp_1:
    ds_read_b32 v10, v8 offset:0
    s_waitcnt lgkmcnt(0)
    v_readfirstlane_b32 s45, v10
    s_sub_u32 s44, s44, 1
    s_cbranch_scc1 spe_2
    s_cmp_ge_u32 s45, 4
    s_cbranch_scc1 spe_2
    s_sleep 0
    s_branch sp_1
spe_2:
    ds_read_b128 a[0:3], v112 offset:16384
    ds_read_b128 a[4:7], v112 offset:49152
    ds_read_b128 a[8:11], v116 offset:16384
    ds_read_b128 a[12:15], v116 offset:49152
    ds_read_b128 a[16:19], v113 offset:16384
    ds_read_b128 a[20:23], v113 offset:49152
    ds_read_b128 a[24:27], v117 offset:16384
    ds_read_b128 a[28:31], v117 offset:49152
    ds_read_b128 a[32:35], v114 offset:16384
    ds_read_b128 a[36:39], v114 offset:49152
    ds_read_b128 a[40:43], v118 offset:16384
    ds_read_b128 a[44:47], v118 offset:49152
    ds_read_b128 a[48:51], v115 offset:16384
    ds_read_b128 a[52:55], v115 offset:49152
    ds_read_b128 a[56:59], v119 offset:16384
    ds_read_b128 a[60:63], v119 offset:49152
    s_waitcnt lgkmcnt(12)
    v_mfma_f32_16x16x32_bf16 v[96:99], a[0:3], v[32:35], 0
    v_mfma_f32_16x16x32_bf16 v[100:103], a[4:7], v[32:35], 0
    v_mfma_f32_16x16x32_bf16 v[104:107], a[8:11], v[32:35], 0
    v_mfma_f32_16x16x32_bf16 v[108:111], a[12:15], v[32:35], 0
    ds_read_b128 a[0:3], v112 offset:16640
    ds_read_b128 a[4:7], v112 offset:49408
    ds_read_b128 a[8:11], v116 offset:16640
    ds_read_b128 a[12:15], v116 offset:49408
    s_waitcnt lgkmcnt(12)
    v_mfma_f32_16x16x32_bf16 v[96:99], a[16:19], v[36:39], v[96:99]
    v_mfma_f32_16x16x32_bf16 v[100:103], a[20:23], v[36:39], v[100:103]
    v_mfma_f32_16x16x32_bf16 v[104:107], a[24:27], v[36:39], v[104:107]
    v_mfma_f32_16x16x32_bf16 v[108:111], a[28:31], v[36:39], v[108:111]
    ds_read_b128 a[16:19], v113 offset:16640
    ds_read_b128 a[20:23], v113 offset:49408
    ds_read_b128 a[24:27], v117 offset:16640
    ds_read_b128 a[28:31], v117 offset:49408
    s_waitcnt lgkmcnt(12)
    v_mfma_f32_16x16x32_bf16 v[96:99], a[32:35], v[40:43], v[96:99]
    v_mfma_f32_16x16x32_bf16 v[100:103], a[36:39], v[40:43], v[100:103]
    v_mfma_f32_16x16x32_bf16 v[104:107], a[40:43], v[40:43], v[104:107]
    v_mfma_f32_16x16x32_bf16 v[108:111], a[44:47], v[40:43], v[108:111]
    ds_read_b128 a[32:35], v114 offset:16640
    ds_read_b128 a[36:39], v114 offset:49408
    ds_read_b128 a[40:43], v118 offset:16640
    ds_read_b128 a[44:47], v118 offset:49408
    s_waitcnt lgkmcnt(12)
    v_mfma_f32_16x16x32_bf16 v[96:99], a[48:51], v[44:47], v[96:99]
    v_mfma_f32_16x16x32_bf16 v[100:103], a[52:55], v[44:47], v[100:103]
    v_mfma_f32_16x16x32_bf16 v[104:107], a[56:59], v[44:47], v[104:107]
    v_mfma_f32_16x16x32_bf16 v[108:111], a[60:63], v[44:47], v[108:111]
    ds_read_b128 a[48:51], v115 offset:16640
    ds_read_b128 a[52:55], v115 offset:49408
    ds_read_b128 a[56:59], v119 offset:16640
    ds_read_b128 a[60:63], v119 offset:49408
    s_waitcnt lgkmcnt(12)
    v_mfma_f32_16x16x32_bf16 v[96:99], a[0:3], v[48:51], v[96:99]
    v_mfma_f32_16x16x32_bf16 v[100:103], a[4:7], v[48:51], v[100:103]
    v_mfma_f32_16x16x32_bf16 v[104:107], a[8:11], v[48:51], v[104:107]
    v_mfma_f32_16x16x32_bf16 v[108:111], a[12:15], v[48:51], v[108:111]
    ds_read_b128 a[0:3], v112 offset:16896
    ds_read_b128 a[4:7], v112 offset:49664
    ds_read_b128 a[8:11], v116 offset:16896
    ds_read_b128 a[12:15], v116 offset:49664
    s_waitcnt lgkmcnt(12)
    v_mfma_f32_16x16x32_bf16 v[96:99], a[16:19], v[52:55], v[96:99]
    v_mfma_f32_16x16x32_bf16 v[100:103], a[20:23], v[52:55], v[100:103]
    v_mfma_f32_16x16x32_bf16 v[104:107], a[24:27], v[52:55], v[104:107]
    v_mfma_f32_16x16x32_bf16 v[108:111], a[28:31], v[52:55], v[108:111]
    ds_read_b128 a[16:19], v113 offset:16896
    ds_read_b128 a[20:23], v113 offset:49664
    ds_read_b128 a[24:27], v117 offset:16896
    ds_read_b128 a[28:31], v117 offset:49664
    s_waitcnt lgkmcnt(12)
    v_mfma_f32_16x16x32_bf16 v[96:99], a[32:35], v[56:59], v[96:99]
    v_mfma_f32_16x16x32_bf16 v[100:103], a[36:39], v[56:59], v[100:103]
    v_mfma_f32_16x16x32_bf16 v[104:107], a[40:43], v[56:59], v[104:107]
    v_mfma_f32_16x16x32_bf16 v[108:111], a[44:47], v[56:59], v[108:111]
    ds_read_b128 a[32:35], v114 offset:16896
    ds_read_b128 a[36:39], v114 offset:49664
    ds_read_b128 a[40:43], v118 offset:16896
    ds_read_b128 a[44:47], v118 offset:49664
    s_waitcnt lgkmcnt(12)
    v_mfma_f32_16x16x32_bf16 v[96:99], a[48:51], v[60:63], v[96:99]
    v_mfma_f32_16x16x32_bf16 v[100:103], a[52:55], v[60:63], v[100:103]
    v_mfma_f32_16x16x32_bf16 v[104:107], a[56:59], v[60:63], v[104:107]
    v_mfma_f32_16x16x32_bf16 v[108:111], a[60:63], v[60:63], v[108:111]
    ds_read_b128 a[48:51], v115 offset:16896
    ds_read_b128 a[52:55], v115 offset:49664
    ds_read_b128 a[56:59], v119 offset:16896
    ds_read_b128 a[60:63], v119 offset:49664
    s_waitcnt lgkmcnt(12)
    v_mfma_f32_16x16x32_bf16 v[96:99], a[0:3], v[64:67], v[96:99]
    v_mfma_f32_16x16x32_bf16 v[100:103], a[4:7], v[64:67], v[100:103]
    v_mfma_f32_16x16x32_bf16 v[104:107], a[8:11], v[64:67], v[104:107]
    v_mfma_f32_16x16x32_bf16 v[108:111], a[12:15], v[64:67], v[108:111]
    ds_read_b128 a[0:3], v112 offset:17152
    ds_read_b128 a[4:7], v112 offset:49920
    ds_read_b128 a[8:11], v116 offset:17152
    ds_read_b128 a[12:15], v116 offset:49920
    s_waitcnt lgkmcnt(12)
    v_mfma_f32_16x16x32_bf16 v[96:99], a[16:19], v[68:71], v[96:99]
    v_mfma_f32_16x16x32_bf16 v[100:103], a[20:23], v[68:71], v[100:103]
    v_mfma_f32_16x16x32_bf16 v[104:107], a[24:27], v[68:71], v[104:107]
    v_mfma_f32_16x16x32_bf16 v[108:111], a[28:31], v[68:71], v[108:111]
    ds_read_b128 a[16:19], v113 offset:17152
    ds_read_b128 a[20:23], v113 offset:49920
    ds_read_b128 a[24:27], v117 offset:17152
    ds_read_b128 a[28:31], v117 offset:49920
    s_waitcnt lgkmcnt(12)
    v_mfma_f32_16x16x32_bf16 v[96:99], a[32:35], v[72:75], v[96:99]
    v_mfma_f32_16x16x32_bf16 v[100:103], a[36:39], v[72:75], v[100:103]
    v_mfma_f32_16x16x32_bf16 v[104:107], a[40:43], v[72:75], v[104:107]
    v_mfma_f32_16x16x32_bf16 v[108:111], a[44:47], v[72:75], v[108:111]
    ds_read_b128 a[32:35], v114 offset:17152
    ds_read_b128 a[36:39], v114 offset:49920
    ds_read_b128 a[40:43], v118 offset:17152
    ds_read_b128 a[44:47], v118 offset:49920
    s_waitcnt lgkmcnt(12)
    v_mfma_f32_16x16x32_bf16 v[96:99], a[48:51], v[76:79], v[96:99]
    v_mfma_f32_16x16x32_bf16 v[100:103], a[52:55], v[76:79], v[100:103]
    v_mfma_f32_16x16x32_bf16 v[104:107], a[56:59], v[76:79], v[104:107]
    v_mfma_f32_16x16x32_bf16 v[108:111], a[60:63], v[76:79], v[108:111]
    ds_read_b128 a[48:51], v115 offset:17152
    ds_read_b128 a[52:55], v115 offset:49920
    ds_read_b128 a[56:59], v119 offset:17152
    ds_read_b128 a[60:63], v119 offset:49920
    s_waitcnt lgkmcnt(12)
    v_mfma_f32_16x16x32_bf16 v[96:99], a[0:3], v[80:83], v[96:99]
    v_mfma_f32_16x16x32_bf16 v[100:103], a[4:7], v[80:83], v[100:103]
    v_mfma_f32_16x16x32_bf16 v[104:107], a[8:11], v[80:83], v[104:107]
    v_mfma_f32_16x16x32_bf16 v[108:111], a[12:15], v[80:83], v[108:111]
    s_waitcnt lgkmcnt(8)
    v_mfma_f32_16x16x32_bf16 v[96:99], a[16:19], v[84:87], v[96:99]
    v_mfma_f32_16x16x32_bf16 v[100:103], a[20:23], v[84:87], v[100:103]
    v_mfma_f32_16x16x32_bf16 v[104:107], a[24:27], v[84:87], v[104:107]
    v_mfma_f32_16x16x32_bf16 v[108:111], a[28:31], v[84:87], v[108:111]
    s_waitcnt lgkmcnt(4)
    v_mfma_f32_16x16x32_bf16 v[96:99], a[32:35], v[88:91], v[96:99]
    v_mfma_f32_16x16x32_bf16 v[100:103], a[36:39], v[88:91], v[100:103]
    v_mfma_f32_16x16x32_bf16 v[104:107], a[40:43], v[88:91], v[104:107]
    v_mfma_f32_16x16x32_bf16 v[108:111], a[44:47], v[88:91], v[108:111]
    s_waitcnt lgkmcnt(0)
    v_mfma_f32_16x16x32_bf16 v[96:99], a[48:51], v[92:95], v[96:99]
    v_mfma_f32_16x16x32_bf16 v[100:103], a[52:55], v[92:95], v[100:103]
    v_mfma_f32_16x16x32_bf16 v[104:107], a[56:59], v[92:95], v[104:107]
    v_mfma_f32_16x16x32_bf16 v[108:111], a[60:63], v[92:95], v[108:111]
    s_nop 4
    v_cvt_pk_bf16_f32 v24, v96, v97
    v_cvt_pk_bf16_f32 v25, v98, v99
    v_cvt_pk_bf16_f32 v26, v100, v101
    v_cvt_pk_bf16_f32 v27, v102, v103
    v_cvt_pk_bf16_f32 v28, v104, v105
    v_cvt_pk_bf16_f32 v29, v106, v107
    v_cvt_pk_bf16_f32 v30, v108, v109
    v_cvt_pk_bf16_f32 v31, v110, v111
    v_cndmask_b32 v32, v28, v24, s[32:33]
    v_cndmask_b32 v33, v29, v25, s[32:33]
    v_cndmask_b32 v34, v30, v26, s[32:33]
    v_cndmask_b32 v35, v31, v27, s[32:33]
    v_mov_b32_dpp v36, v32 row_ror:8 row_mask:0xf bank_mask:0xf
    v_mov_b32_dpp v37, v33 row_ror:8 row_mask:0xf bank_mask:0xf
    v_mov_b32_dpp v38, v34 row_ror:8 row_mask:0xf bank_mask:0xf
    v_mov_b32_dpp v39, v35 row_ror:8 row_mask:0xf bank_mask:0xf
    v_cndmask_b32 v40, v24, v36, s[32:33]
    v_cndmask_b32 v41, v25, v37, s[32:33]
    v_cndmask_b32 v42, v26, v38, s[32:33]
    v_cndmask_b32 v43, v27, v39, s[32:33]
    v_cndmask_b32 v44, v36, v28, s[32:33]
    v_cndmask_b32 v45, v37, v29, s[32:33]
    v_cndmask_b32 v46, v38, v30, s[32:33]
    v_cndmask_b32 v47, v39, v31, s[32:33]
    buffer_store_dwordx4 v[40:43], v120, s[12:15], s30 offen sc1
    buffer_store_dwordx4 v[44:47], v120, s[12:15], s31 offen sc1
    v_and_b32 v3, 15, v2
    v_lshrrev_b32 v4, 4, v2
    s_lshl_b32 s29, s3, 4
    v_add_u32 v6, s29, v3
    v_lshlrev_b32 v7, 7, v6
    v_lshl_add_u32 v7, v4, 5, v7
    v_cvt_f32_u32 v13, v6
    v_mul_f32 v13, 0x3c800000, v13
    v_lshlrev_b32 v16, 3, v4
    v_cvt_f32_u32 v16, v16
    v_mul_f32 v14, v13, v16
    v_mov_b32 v96, v14
    v_fma_f32 v97, v13, 1.0, v14
    v_fma_f32 v98, v13, 2.0, v14
    v_fmamk_f32 v99, v13, 0x40400000, v14
    v_fma_f32 v100, v13, 4.0, v14
    v_fmamk_f32 v101, v13, 0x40a00000, v14
    v_fmamk_f32 v102, v13, 0x40c00000, v14
    v_fmamk_f32 v103, v13, 0x40e00000, v14
    v_sin_f32 v104, v96
    v_cos_f32 v96, v96
    v_sin_f32 v105, v97
    v_cos_f32 v97, v97
    v_sin_f32 v106, v98
    v_cos_f32 v98, v98
    v_sin_f32 v107, v99
    v_cos_f32 v99, v99
    v_sin_f32 v108, v100
    v_cos_f32 v100, v100
    v_sin_f32 v109, v101
    v_cos_f32 v101, v101
    v_sin_f32 v110, v102
    v_cos_f32 v102, v102
    v_sin_f32 v111, v103
    v_cos_f32 v103, v103
    v_cvt_pk_bf16_f32 v112, v96, v97
    v_cvt_pk_bf16_f32 v116, v104, v105
    v_cvt_pk_bf16_f32 v113, v98, v99
    v_cvt_pk_bf16_f32 v117, v106, v107
    v_cvt_pk_bf16_f32 v114, v100, v101
    v_cvt_pk_bf16_f32 v118, v108, v109
    v_cvt_pk_bf16_f32 v115, v102, v103
    v_cvt_pk_bf16_f32 v119, v110, v111
    v_xor_b32 v120, 0x80008000, v116
    v_accvgpr_write_b32 a0, v112
    v_accvgpr_write_b32 a8, v116
    v_xor_b32 v121, 0x80008000, v117
    v_accvgpr_write_b32 a1, v113
    v_accvgpr_write_b32 a9, v117
    v_xor_b32 v122, 0x80008000, v118
    v_accvgpr_write_b32 a2, v114
    v_accvgpr_write_b32 a10, v118
    v_xor_b32 v123, 0x80008000, v119
    v_accvgpr_write_b32 a3, v115
    v_accvgpr_write_b32 a11, v119
    v_accvgpr_write_b32 a16, v120
    v_accvgpr_write_b32 a17, v121
    v_accvgpr_write_b32 a18, v122
    v_accvgpr_write_b32 a19, v123
    s_waitcnt vmcnt(0)
    s_mov_b64 exec, 1
    ds_add_rtn_u32 v10, v8, v9 offset:4
    s_mov_b64 exec, -1
    s_waitcnt lgkmcnt(0)
    v_readfirstlane_b32 s45, v10
    s_nop 1
    s_cmp_lg_u32 s45, 7
    s_cbranch_scc1 pube_3
    s_setprio 3
    s_mov_b32 s44, 524288
sp_4:
    ds_read_b32 v10, v8 offset:40
    s_waitcnt lgkmcnt(0)
    v_readfirstlane_b32 s45, v10
    s_sub_u32 s44, s44, 1
    s_cbranch_scc1 spe_5
    s_cmp_ge_u32 s45, 1
    s_cbranch_scc1 spe_5
    s_sleep 1
    s_branch sp_4
spe_5:
    v_mov_b32 v10, s45
    s_mov_b32 s44, 10551296
    s_mov_b64 exec, 255
    buffer_store_dword v10, v11, s[12:15], s44 offen sc1
    s_mov_b64 exec, 1
    ds_write_b32 v8, v9 offset:52
    s_mov_b64 exec, -1
    s_setprio 0
pube_3:
    v_fmamk_f32 v96, v13, 0x42000000, v14
    v_fmamk_f32 v97, v13, 0x42040000, v14
    v_fmamk_f32 v98, v13, 0x42080000, v14
    v_fmamk_f32 v99, v13, 0x420c0000, v14
    v_fmamk_f32 v100, v13, 0x42100000, v14
    v_fmamk_f32 v101, v13, 0x42140000, v14
    v_fmamk_f32 v102, v13, 0x42180000, v14
    v_fmamk_f32 v103, v13, 0x421c0000, v14
    v_sin_f32 v104, v96
    v_cos_f32 v96, v96
    v_sin_f32 v105, v97
    v_cos_f32 v97, v97
    v_sin_f32 v106, v98
    v_cos_f32 v98, v98
    v_sin_f32 v107, v99
    v_cos_f32 v99, v99
    v_sin_f32 v108, v100
    v_cos_f32 v100, v100
    v_sin_f32 v109, v101
    v_cos_f32 v101, v101
    v_sin_f32 v110, v102
    v_cos_f32 v102, v102
    v_sin_f32 v111, v103
    v_cos_f32 v103, v103
    v_cvt_pk_bf16_f32 v112, v96, v97
    v_cvt_pk_bf16_f32 v116, v104, v105
    v_cvt_pk_bf16_f32 v113, v98, v99
    v_cvt_pk_bf16_f32 v117, v106, v107
    v_cvt_pk_bf16_f32 v114, v100, v101
    v_cvt_pk_bf16_f32 v118, v108, v109
    v_cvt_pk_bf16_f32 v115, v102, v103
    v_cvt_pk_bf16_f32 v119, v110, v111
    v_xor_b32 v120, 0x80008000, v116
    v_accvgpr_write_b32 a4, v112
    v_accvgpr_write_b32 a12, v116
    v_xor_b32 v121, 0x80008000, v117
    v_accvgpr_write_b32 a5, v113
    v_accvgpr_write_b32 a13, v117
    v_xor_b32 v122, 0x80008000, v118
    v_accvgpr_write_b32 a6, v114
    v_accvgpr_write_b32 a14, v118
    v_xor_b32 v123, 0x80008000, v119
    v_accvgpr_write_b32 a7, v115
    v_accvgpr_write_b32 a15, v119
    v_accvgpr_write_b32 a20, v120
    v_accvgpr_write_b32 a21, v121
    v_accvgpr_write_b32 a22, v122
    v_accvgpr_write_b32 a23, v123
    v_lshlrev_b32 v17, 2, v4
    v_cvt_f32_u32 v17, v17
    v_cvt_f32_u32 v15, v3
    v_add_f32 v18, 0x00000000, v15
    v_mul_f32 v18, 0x3d000000, v18
    v_mul_f32 v19, v18, v17
    v_mov_b32 v96, v19
    v_fma_f32 v97, v18, 1.0, v19
    v_fma_f32 v98, v18, 2.0, v19
    v_fmamk_f32 v99, v18, 0x40400000, v19
    v_fmamk_f32 v100, v18, 0x41800000, v19
    v_fmamk_f32 v101, v18, 0x41880000, v19
    v_fmamk_f32 v102, v18, 0x41900000, v19
    v_fmamk_f32 v103, v18, 0x41980000, v19
    v_sin_f32 v104, v96
    v_cos_f32 v96, v96
    v_sin_f32 v105, v97
    v_cos_f32 v97, v97
    v_sin_f32 v106, v98
    v_cos_f32 v98, v98
    v_sin_f32 v107, v99
    v_cos_f32 v99, v99
    v_sin_f32 v108, v100
    v_cos_f32 v100, v100
    v_sin_f32 v109, v101
    v_cos_f32 v101, v101
    v_sin_f32 v110, v102
    v_cos_f32 v102, v102
    v_sin_f32 v111, v103
    v_cos_f32 v103, v103
    v_cvt_pk_bf16_f32 v112, v96, v97
    v_cvt_pk_bf16_f32 v116, v104, v105
    v_cvt_pk_bf16_f32 v113, v98, v99
    v_cvt_pk_bf16_f32 v117, v106, v107
    v_cvt_pk_bf16_f32 v114, v100, v101
    v_cvt_pk_bf16_f32 v118, v108, v109
    v_cvt_pk_bf16_f32 v115, v102, v103
    v_cvt_pk_bf16_f32 v119, v110, v111
    v_xor_b32 v120, 0x80008000, v116
    v_accvgpr_write_b32 a24, v112
    v_accvgpr_write_b32 a32, v116
    v_xor_b32 v121, 0x80008000, v117
    v_accvgpr_write_b32 a25, v113
    v_accvgpr_write_b32 a33, v117
    v_xor_b32 v122, 0x80008000, v118
    v_accvgpr_write_b32 a26, v114
    v_accvgpr_write_b32 a34, v118
    v_xor_b32 v123, 0x80008000, v119
    v_accvgpr_write_b32 a27, v115
    v_accvgpr_write_b32 a35, v119
    v_accvgpr_write_b32 a40, v120
    v_accvgpr_write_b32 a41, v121
    v_accvgpr_write_b32 a42, v122
    v_accvgpr_write_b32 a43, v123
    v_add_f32 v18, 0x41800000, v15
    v_mul_f32 v18, 0x3d000000, v18
    v_mul_f32 v19, v18, v17
    v_mov_b32 v96, v19
    v_fma_f32 v97, v18, 1.0, v19
    v_fma_f32 v98, v18, 2.0, v19
    v_fmamk_f32 v99, v18, 0x40400000, v19
    v_fmamk_f32 v100, v18, 0x41800000, v19
    v_fmamk_f32 v101, v18, 0x41880000, v19
    v_fmamk_f32 v102, v18, 0x41900000, v19
    v_fmamk_f32 v103, v18, 0x41980000, v19
    v_sin_f32 v104, v96
    v_cos_f32 v96, v96
    v_sin_f32 v105, v97
    v_cos_f32 v97, v97
    v_sin_f32 v106, v98
    v_cos_f32 v98, v98
    v_sin_f32 v107, v99
    v_cos_f32 v99, v99
    v_sin_f32 v108, v100
    v_cos_f32 v100, v100
    v_sin_f32 v109, v101
    v_cos_f32 v101, v101
    v_sin_f32 v110, v102
    v_cos_f32 v102, v102
    v_sin_f32 v111, v103
    v_cos_f32 v103, v103
    v_cvt_pk_bf16_f32 v112, v96, v97
    v_cvt_pk_bf16_f32 v116, v104, v105
    v_cvt_pk_bf16_f32 v113, v98, v99
    v_cvt_pk_bf16_f32 v117, v106, v107
    v_cvt_pk_bf16_f32 v114, v100, v101
    v_cvt_pk_bf16_f32 v118, v108, v109
    v_cvt_pk_bf16_f32 v115, v102, v103
    v_cvt_pk_bf16_f32 v119, v110, v111
    v_xor_b32 v120, 0x80008000, v116
    v_accvgpr_write_b32 a28, v112
    v_accvgpr_write_b32 a36, v116
    v_xor_b32 v121, 0x80008000, v117
    v_accvgpr_write_b32 a29, v113
    v_accvgpr_write_b32 a37, v117
    v_xor_b32 v122, 0x80008000, v118
    v_accvgpr_write_b32 a30, v114
    v_accvgpr_write_b32 a38, v118
    v_xor_b32 v123, 0x80008000, v119
    v_accvgpr_write_b32 a31, v115
    v_accvgpr_write_b32 a39, v119
    v_accvgpr_write_b32 a44, v120
    v_accvgpr_write_b32 a45, v121
    v_accvgpr_write_b32 a46, v122
    v_accvgpr_write_b32 a47, v123
    v_mul_f32 v18, 0x3d000000, v13
    v_mul_f32 v19, v18, v17
    v_mov_b32 v64, v19
    v_fma_f32 v65, v18, 1.0, v19
    v_fma_f32 v66, v18, 2.0, v19
    v_fmamk_f32 v67, v18, 0x40400000, v19
    v_fmamk_f32 v68, v18, 0x41800000, v19
    v_fmamk_f32 v69, v18, 0x41880000, v19
    v_fmamk_f32 v70, v18, 0x41900000, v19
    v_fmamk_f32 v71, v18, 0x41980000, v19
    v_sin_f32 v72, v64
    v_cos_f32 v64, v64
    v_sin_f32 v73, v65
    v_cos_f32 v65, v65
    v_sin_f32 v74, v66
    v_cos_f32 v66, v66
    v_sin_f32 v75, v67
    v_cos_f32 v67, v67
    v_sin_f32 v76, v68
    v_cos_f32 v68, v68
    v_sin_f32 v77, v69
    v_cos_f32 v69, v69
    v_sin_f32 v78, v70
    v_cos_f32 v70, v70
    v_sin_f32 v79, v71
    v_cos_f32 v71, v71
    v_cvt_f32_u32 v20, s29
    v_add_f32 v20, v20, v17
    v_add_f32 v18, 0x00000000, v15
    v_mul_f32 v18, 0x3a000000, v18
    v_mul_f32 v19, v18, v20
    v_mov_b32 v80, v19
    v_fma_f32 v81, v18, 1.0, v19
    v_fma_f32 v82, v18, 2.0, v19
    v_fmamk_f32 v83, v18, 0x40400000, v19
    v_add_f32 v18, 0x41800000, v15
    v_mul_f32 v18, 0x3a000000, v18
    v_mul_f32 v19, v18, v20
    v_mov_b32 v84, v19
    v_fma_f32 v85, v18, 1.0, v19
    v_fma_f32 v86, v18, 2.0, v19
    v_fmamk_f32 v87, v18, 0x40400000, v19
    v_sin_f32 v88, v80
    v_cos_f32 v80, v80
    v_sin_f32 v89, v81
    v_cos_f32 v81, v81
    v_sin_f32 v90, v82
    v_cos_f32 v82, v82
    v_sin_f32 v91, v83
    v_cos_f32 v83, v83
    v_sin_f32 v92, v84
    v_cos_f32 v84, v84
    v_sin_f32 v93, v85
    v_cos_f32 v85, v85
    v_sin_f32 v94, v86
    v_cos_f32 v86, v86
    v_sin_f32 v95, v87
    v_cos_f32 v87, v87
    v_mul_u32_u24 v21, 144, v3
    v_lshl_add_u32 v21, v4, 3, v21
    s_lshl_b32 s36, s3, 5
    s_add_u32 s36, s36, 131072
    v_add_u32 v21, s36, v21
    v_lshrrev_b32 v22, 2, v3
    v_lshlrev_b32 v22, 3, v22
    v_and_b32 v18, 3, v3
    v_add_u32 v22, v22, v18
    v_mul_u32_u24 v22, 144, v22
    v_lshl_add_u32 v22, v4, 4, v22
    v_add_u32 v22, 131072, v22
    v_lshrrev_b32 v23, 1, v6
    v_lshlrev_b32 v23, 16, v23
    v_and_b32 v18, 1, v3
    v_lshl_add_u32 v23, v18, 6, v23
    v_lshl_add_u32 v23, v4, 4, v23
    s_add_u32 s27, s2, 1
    s_mov_b32 s28, 0
    s_and_b32 s27, s27, 255
    s_cmp_eq_u32 s2, 255
    s_cselect_b32 s28, 1, 0
    s_mov_b32 s40, 4
    s_lshl_b32 s41, s3, 11
    s_add_u32 s41, s41, 140288
    v_add_u32 v13, 140288, v5
    s_cmp_lg_u32 s3, 0
    s_cbranch_scc1 f_wait1
    s_setprio 3
    s_mov_b32 s44, 524288
sp_8:
    ds_read_b32 v10, v8 offset:40
    s_waitcnt lgkmcnt(0)
    v_readfirstlane_b32 s45, v10
    s_sub_u32 s44, s44, 1
    s_cbranch_scc1 spe_9
    s_cmp_ge_u32 s45, 1
    s_cbranch_scc1 spe_9
    s_sleep 1
    s_branch sp_8
spe_9:
    s_mov_b32 s46, s45
    s_lshl_b32 s47, s22, 12
    s_add_u32 s47, s47, 10551296
    s_mov_b32 s44, 65536
pl_6:
    buffer_load_dwordx4 v[96:99], v12, s[12:15], s47 offen sc1
    s_waitcnt vmcnt(0)
    v_xor_b32 v96, s46, v96
    v_xor_b32 v97, s46, v97
    v_xor_b32 v98, s46, v98
    v_xor_b32 v99, s46, v99
    v_or_b32 v96, v96, v97
    v_or3_b32 v96, v96, v98, v99
    v_cmp_ne_u32 vcc, 0, v96
    s_sub_u32 s44, s44, 1
    s_cbranch_scc1 ple_7
    s_cbranch_vccz ple_7
    s_sleep 2
    s_branch pl_6
ple_7:
    s_mov_b64 exec, 1
    ds_write_b32 v8, v9 offset:8
    s_mov_b64 exec, -1
    s_setprio 0
f_wait1:
    s_mov_b32 s44, 524288
sp_10:
    ds_read_b32 v10, v8 offset:8
    s_waitcnt lgkmcnt(0)
    v_readfirstlane_b32 s45, v10
    s_sub_u32 s44, s44, 1
    s_cbranch_scc1 spe_11
    s_cmp_ge_u32 s45, 1
    s_cbranch_scc1 spe_11
    s_sleep 1
    s_branch sp_10
spe_11:
f_task:
    s_lshl_b32 s30, s27, 13
    s_lshr_b32 s36, s28, 1
    s_lshl_b32 s37, s36, 21
    s_add_u32 s31, s30, s37
    s_add_u32 s31, s31, 7340032
    s_lshl_b32 s37, s36, 12
    s_add_u32 s30, s30, s37
    s_add_u32 s30, s30, 4194304
    s_lshl_b32 s37, s3, 11
    s_add_u32 s31, s31, s37
    s_add_u32 s30, s30, s37
    s_mov_b32 s37, 10485760
    s_lshl_b32 s38, s27, 8
    s_lshl_b32 s36, s36, 7
    s_add_u32 s38, s38, s36
    s_add_u32 s38, s38, 14680064
    s_mov_b32 m0, s41
    s_setprio 3
    buffer_load_dwordx4 v5, s[12:15], s30 offen sc1 lds
    buffer_load_dwordx4 v5, s[12:15], s30 offen offset:1024 sc1 lds
    buffer_load_dwordx4 v[48:51], v5, s[12:15], s31 offen offset:0 sc1
    buffer_load_dwordx4 v[52:55], v5, s[12:15], s31 offen offset:1024 sc1
    buffer_load_dwordx4 v[56:59], v7, s[12:15], s37 offen offset:0 sc1
    buffer_load_dwordx4 v[60:63], v7, s[12:15], s37 offen offset:16 sc1
    s_setprio 1
    s_waitcnt vmcnt(4)
    s_mov_b64 exec, 1
    ds_add_u32 v8, v9 offset:60
    s_mov_b64 exec, -1
    s_mov_b32 s44, 524288
sp_12:
    ds_read_b32 v10, v8 offset:60
    s_waitcnt lgkmcnt(0)
    v_readfirstlane_b32 s45, v10
    s_sub_u32 s44, s44, 1
    s_cbranch_scc1 spe_13
    s_cmp_ge_u32 s45, s40
    s_cbranch_scc1 spe_13
    s_sleep 0
    s_branch sp_12
spe_13:
    ds_read_b128 a[48:51], v13 offset:0
    ds_read_b128 a[52:55], v13 offset:1024
    ds_read_b128 a[56:59], v13 offset:2048
    ds_read_b128 a[60:63], v13 offset:3072
    ds_read_b128 a[64:67], v13 offset:4096
    ds_read_b128 a[68:71], v13 offset:5120
    ds_read_b128 a[72:75], v13 offset:6144
    ds_read_b128 a[76:79], v13 offset:7168
    s_waitcnt lgkmcnt(0)
    s_cmp_eq_u32 s28, 0
    s_cbranch_scc1 f_cplx
    v_accvgpr_write_b32 a64, 0
    v_accvgpr_write_b32 a65, 0
    v_accvgpr_write_b32 a66, 0
    v_accvgpr_write_b32 a67, 0
    v_accvgpr_write_b32 a68, 0
    v_accvgpr_write_b32 a69, 0
    v_accvgpr_write_b32 a70, 0
    v_accvgpr_write_b32 a71, 0
    v_accvgpr_write_b32 a72, 0
    v_accvgpr_write_b32 a73, 0
    v_accvgpr_write_b32 a74, 0
    v_accvgpr_write_b32 a75, 0
    v_accvgpr_write_b32 a76, 0
    v_accvgpr_write_b32 a77, 0
    v_accvgpr_write_b32 a78, 0
    v_accvgpr_write_b32 a79, 0
f_cplx:
    s_nop 1
    v_mfma_f32_16x16x32_bf16 v[24:27], a[48:51], a[0:3], 0
    v_mfma_f32_16x16x32_bf16 v[32:35], a[64:67], a[0:3], 0
    v_mfma_f32_16x16x32_bf16 v[28:31], a[56:59], a[0:3], 0
    v_mfma_f32_16x16x32_bf16 v[36:39], a[72:75], a[0:3], 0
    v_mfma_f32_16x16x32_bf16 v[24:27], a[64:67], a[8:11], v[24:27]
    v_mfma_f32_16x16x32_bf16 v[32:35], a[48:51], a[16:19], v[32:35]
    v_mfma_f32_16x16x32_bf16 v[28:31], a[72:75], a[8:11], v[28:31]
    v_mfma_f32_16x16x32_bf16 v[36:39], a[56:59], a[16:19], v[36:39]
    v_mfma_f32_16x16x32_bf16 v[24:27], a[52:55], a[4:7], v[24:27]
    v_mfma_f32_16x16x32_bf16 v[32:35], a[68:71], a[4:7], v[32:35]
    v_mfma_f32_16x16x32_bf16 v[28:31], a[60:63], a[4:7], v[28:31]
    v_mfma_f32_16x16x32_bf16 v[36:39], a[76:79], a[4:7], v[36:39]
    v_mfma_f32_16x16x32_bf16 v[24:27], a[68:71], a[12:15], v[24:27]
    v_mfma_f32_16x16x32_bf16 v[32:35], a[52:55], a[20:23], v[32:35]
    v_mfma_f32_16x16x32_bf16 v[28:31], a[76:79], a[12:15], v[28:31]
    v_mfma_f32_16x16x32_bf16 v[36:39], a[60:63], a[20:23], v[36:39]
    s_waitcnt vmcnt(2)
    v_lshlrev_b32 v112, 16, v48
    v_and_b32 v120, 0xffff0000, v48
    v_lshlrev_b32 v113, 16, v49
    v_and_b32 v121, 0xffff0000, v49
    v_lshlrev_b32 v114, 16, v50
    v_and_b32 v122, 0xffff0000, v50
    v_lshlrev_b32 v115, 16, v51
    v_and_b32 v123, 0xffff0000, v51
    v_lshlrev_b32 v116, 16, v52
    v_and_b32 v124, 0xffff0000, v52
    v_lshlrev_b32 v117, 16, v53
    v_and_b32 v125, 0xffff0000, v53
    v_lshlrev_b32 v118, 16, v54
    v_and_b32 v126, 0xffff0000, v54
    v_lshlrev_b32 v119, 16, v55
    v_and_b32 v127, 0xffff0000, v55
    v_mul_f32 v96, v24, v64
    v_mul_f32 v104, v32, v64
    v_mul_f32 v97, v25, v65
    v_mul_f32 v105, v33, v65
    v_mul_f32 v98, v26, v66
    v_mul_f32 v106, v34, v66
    v_mul_f32 v99, v27, v67
    v_mul_f32 v107, v35, v67
    v_mul_f32 v100, v28, v68
    v_mul_f32 v108, v36, v68
    v_mul_f32 v101, v29, v69
    v_mul_f32 v109, v37, v69
    v_mul_f32 v102, v30, v70
    v_mul_f32 v110, v38, v70
    v_mul_f32 v103, v31, v71
    v_mul_f32 v111, v39, v71
    v_fma_f32 v96, v32, v72, v96
    v_fma_f32 v104, -v24, v72, v104
    v_fma_f32 v97, v33, v73, v97
    v_fma_f32 v105, -v25, v73, v105
    v_fma_f32 v98, v34, v74, v98
    v_fma_f32 v106, -v26, v74, v106
    v_fma_f32 v99, v35, v75, v99
    v_fma_f32 v107, -v27, v75, v107
    v_fma_f32 v100, v36, v76, v100
    v_fma_f32 v108, -v28, v76, v108
    v_fma_f32 v101, v37, v77, v101
    v_fma_f32 v109, -v29, v77, v109
    v_fma_f32 v102, v38, v78, v102
    v_fma_f32 v110, -v30, v78, v110
    v_fma_f32 v103, v39, v79, v103
    v_fma_f32 v111, -v31, v79, v111
    v_cvt_pk_bf16_f32 v40, v96, v97
    v_cvt_pk_bf16_f32 v41, v98, v99
    v_cvt_pk_bf16_f32 v42, v100, v101
    v_cvt_pk_bf16_f32 v43, v102, v103
    v_cvt_pk_bf16_f32 v44, v104, v105
    v_cvt_pk_bf16_f32 v45, v106, v107
    v_cvt_pk_bf16_f32 v46, v108, v109
    v_cvt_pk_bf16_f32 v47, v110, v111
    v_mfma_f32_16x16x32_bf16 v[24:27], a[24:27], v[40:43], 0
    s_nop 0
    v_mfma_f32_16x16x32_bf16 v[32:35], a[24:27], v[44:47], 0
    v_mfma_f32_16x16x32_bf16 v[28:31], a[28:31], v[40:43], 0
    v_mfma_f32_16x16x32_bf16 v[36:39], a[28:31], v[44:47], 0
    v_mfma_f32_16x16x32_bf16 v[24:27], a[32:35], v[44:47], v[24:27]
    v_mfma_f32_16x16x32_bf16 v[32:35], a[40:43], v[40:43], v[32:35]
    v_mfma_f32_16x16x32_bf16 v[28:31], a[36:39], v[44:47], v[28:31]
    v_mfma_f32_16x16x32_bf16 v[36:39], a[44:47], v[40:43], v[36:39]
    s_nop 4
    v_mul_f32 v96, v24, v112
    v_mul_f32 v104, v32, v112
    v_mul_f32 v97, v25, v113
    v_mul_f32 v105, v33, v113
    v_mul_f32 v98, v26, v114
    v_mul_f32 v106, v34, v114
    v_mul_f32 v99, v27, v115
    v_mul_f32 v107, v35, v115
    v_mul_f32 v100, v28, v116
    v_mul_f32 v108, v36, v116
    v_mul_f32 v101, v29, v117
    v_mul_f32 v109, v37, v117
    v_mul_f32 v102, v30, v118
    v_mul_f32 v110, v38, v118
    v_mul_f32 v103, v31, v119
    v_mul_f32 v111, v39, v119
    v_fma_f32 v96, -v32, v120, v96
    v_fma_f32 v104, v24, v120, v104
    v_fma_f32 v97, -v33, v121, v97
    v_fma_f32 v105, v25, v121, v105
    v_fma_f32 v98, -v34, v122, v98
    v_fma_f32 v106, v26, v122, v106
    v_fma_f32 v99, -v35, v123, v99
    v_fma_f32 v107, v27, v123, v107
    v_fma_f32 v100, -v36, v124, v100
    v_fma_f32 v108, v28, v124, v108
    v_fma_f32 v101, -v37, v125, v101
    v_fma_f32 v109, v29, v125, v109
    v_fma_f32 v102, -v38, v126, v102
    v_fma_f32 v110, v30, v126, v110
    v_fma_f32 v103, -v39, v127, v103
    v_fma_f32 v111, v31, v127, v111
    v_cvt_pk_bf16_f32 v40, v96, v97
    v_cvt_pk_bf16_f32 v41, v98, v99
    v_cvt_pk_bf16_f32 v42, v100, v101
    v_cvt_pk_bf16_f32 v43, v102, v103
    v_cvt_pk_bf16_f32 v44, v104, v105
    v_cvt_pk_bf16_f32 v45, v106, v107
    v_cvt_pk_bf16_f32 v46, v108, v109
    v_cvt_pk_bf16_f32 v47, v110, v111
    v_mfma_f32_16x16x32_bf16 v[24:27], v[40:43], a[24:27], 0
    s_nop 0
    v_mfma_f32_16x16x32_bf16 v[32:35], v[44:47], a[24:27], 0
    v_mfma_f32_16x16x32_bf16 v[28:31], v[40:43], a[28:31], 0
    v_mfma_f32_16x16x32_bf16 v[36:39], v[44:47], a[28:31], 0
    v_mfma_f32_16x16x32_bf16 v[24:27], v[44:47], a[40:43], v[24:27]
    v_mfma_f32_16x16x32_bf16 v[32:35], v[40:43], a[32:35], v[32:35]
    v_mfma_f32_16x16x32_bf16 v[28:31], v[44:47], a[44:47], v[28:31]
    v_mfma_f32_16x16x32_bf16 v[36:39], v[40:43], a[36:39], v[36:39]
    s_nop 4
    v_mul_f32 v96, v24, v80
    v_mul_f32 v104, v32, v80
    v_mul_f32 v97, v25, v81
    v_mul_f32 v105, v33, v81
    v_mul_f32 v98, v26, v82
    v_mul_f32 v106, v34, v82
    v_mul_f32 v99, v27, v83
    v_mul_f32 v107, v35, v83
    v_mul_f32 v100, v28, v84
    v_mul_f32 v108, v36, v84
    v_mul_f32 v101, v29, v85
    v_mul_f32 v109, v37, v85
    v_mul_f32 v102, v30, v86
    v_mul_f32 v110, v38, v86
    v_mul_f32 v103, v31, v87
    v_mul_f32 v111, v39, v87
    v_fma_f32 v96, -v32, v88, v96
    v_fma_f32 v104, v24, v88, v104
    v_fma_f32 v97, -v33, v89, v97
    v_fma_f32 v105, v25, v89, v105
    v_fma_f32 v98, -v34, v90, v98
    v_fma_f32 v106, v26, v90, v106
    v_fma_f32 v99, -v35, v91, v99
    v_fma_f32 v107, v27, v91, v107
    v_fma_f32 v100, -v36, v92, v100
    v_fma_f32 v108, v28, v92, v108
    v_fma_f32 v101, -v37, v93, v101
    v_fma_f32 v109, v29, v93, v109
    v_fma_f32 v102, -v38, v94, v102
    v_fma_f32 v110, v30, v94, v110
    v_fma_f32 v103, -v39, v95, v103
    v_fma_f32 v111, v31, v95, v111
    v_cvt_pk_bf16_f32 v40, v96, v97
    v_cvt_pk_bf16_f32 v41, v98, v99
    v_cvt_pk_bf16_f32 v42, v100, v101
    v_cvt_pk_bf16_f32 v43, v102, v103
    v_cvt_pk_bf16_f32 v44, v104, v105
    v_cvt_pk_bf16_f32 v45, v106, v107
    v_cvt_pk_bf16_f32 v46, v108, v109
    v_cvt_pk_bf16_f32 v47, v110, v111
    ds_write_b64 v21, v[40:41] offset:0
    ds_write_b64 v21, v[42:43] offset:2304
    ds_write_b64 v21, v[44:45] offset:4608
    ds_write_b64 v21, v[46:47] offset:6912
    s_waitcnt lgkmcnt(0)
    s_mov_b64 exec, 1
    ds_add_u32 v8, v9 offset:12
    s_mov_b64 exec, -1
    s_mov_b32 s44, 524288
sp_14:
    ds_read_b32 v10, v8 offset:12
    s_waitcnt lgkmcnt(0)
    v_readfirstlane_b32 s45, v10
    s_sub_u32 s44, s44, 1
    s_cbranch_scc1 spe_15
    s_cmp_ge_u32 s45, s40
    s_cbranch_scc1 spe_15
    s_sleep 0
    s_branch sp_14
spe_15:
    ds_read_b128 a[48:51], v22 offset:0
    ds_read_b128 a[52:55], v22 offset:64
    ds_read_b128 a[56:59], v22 offset:576
    ds_read_b128 a[60:63], v22 offset:640
    ds_read_b128 a[64:67], v22 offset:4608
    ds_read_b128 a[68:71], v22 offset:4672
    ds_read_b128 a[72:75], v22 offset:5184
    ds_read_b128 a[76:79], v22 offset:5248
    s_waitcnt lgkmcnt(0)
    s_mov_b64 exec, 1
    ds_add_u32 v8, v9 offset:48
    s_mov_b64 exec, -1
    v_mfma_f32_16x16x32_bf16 v[24:27], a[48:51], a[0:3], 0
    v_mfma_f32_16x16x32_bf16 v[32:35], a[64:67], a[0:3], 0
    v_mfma_f32_16x16x32_bf16 v[28:31], a[56:59], a[0:3], 0
    v_mfma_f32_16x16x32_bf16 v[36:39], a[72:75], a[0:3], 0
    v_mfma_f32_16x16x32_bf16 v[24:27], a[64:67], a[16:19], v[24:27]
    v_mfma_f32_16x16x32_bf16 v[32:35], a[48:51], a[8:11], v[32:35]
    v_mfma_f32_16x16x32_bf16 v[28:31], a[72:75], a[16:19], v[28:31]
    v_mfma_f32_16x16x32_bf16 v[36:39], a[56:59], a[8:11], v[36:39]
    v_mfma_f32_16x16x32_bf16 v[24:27], a[52:55], a[4:7], v[24:27]
    v_mfma_f32_16x16x32_bf16 v[32:35], a[68:71], a[4:7], v[32:35]
    v_mfma_f32_16x16x32_bf16 v[28:31], a[60:63], a[4:7], v[28:31]
    v_mfma_f32_16x16x32_bf16 v[36:39], a[76:79], a[4:7], v[36:39]
    v_mfma_f32_16x16x32_bf16 v[24:27], a[68:71], a[20:23], v[24:27]
    v_mfma_f32_16x16x32_bf16 v[32:35], a[52:55], a[12:15], v[32:35]
    v_mfma_f32_16x16x32_bf16 v[28:31], a[76:79], a[20:23], v[28:31]
    v_mfma_f32_16x16x32_bf16 v[36:39], a[60:63], a[12:15], v[36:39]
    s_waitcnt vmcnt(0)
    s_nop 3
    v_mul_f32 v96, v24, v56
    v_mul_f32 v97, v25, v57
    v_mul_f32 v98, v26, v58
    v_mul_f32 v99, v27, v59
    v_mul_f32 v100, v28, v60
    v_mul_f32 v101, v29, v61
    v_mul_f32 v102, v30, v62
    v_mul_f32 v103, v31, v63
    v_mul_f32 v104, v32, v56
    v_mul_f32 v105, v33, v57
    v_mul_f32 v106, v34, v58
    v_mul_f32 v107, v35, v59
    v_mul_f32 v108, v36, v60
    v_mul_f32 v109, v37, v61
    v_mul_f32 v110, v38, v62
    v_mul_f32 v111, v39, v63
    v_cvt_pk_bf16_f32 v40, v96, v97
    v_cvt_pk_bf16_f32 v41, v98, v99
    v_cvt_pk_bf16_f32 v42, v100, v101
    v_cvt_pk_bf16_f32 v43, v102, v103
    v_cvt_pk_bf16_f32 v44, v104, v105
    v_cvt_pk_bf16_f32 v45, v106, v107
    v_cvt_pk_bf16_f32 v46, v108, v109
    v_cvt_pk_bf16_f32 v47, v110, v111
    buffer_store_dwordx4 v[40:43], v23, s[12:15], s38 offen sc1
    s_cmp_lg_u32 s28, 0
    s_cbranch_scc1 f_noim
    buffer_store_dwordx4 v[44:47], v23, s[12:15], s38 offen offset:128 sc1
f_noim:
    s_cmp_eq_u32 s40, 8
    s_cbranch_scc1 f_done2
    s_cmp_lg_u32 s2, 255
    s_cbranch_scc1 f_done2
    s_mov_b32 s28, 2
    s_mov_b32 s27, 0
    s_mov_b32 s40, 8
    s_mov_b32 s44, 524288
sp_16:
    ds_read_b32 v10, v8 offset:48
    s_waitcnt lgkmcnt(0)
    v_readfirstlane_b32 s45, v10
    s_sub_u32 s44, s44, 1
    s_cbranch_scc1 spe_17
    s_cmp_ge_u32 s45, 4
    s_cbranch_scc1 spe_17
    s_sleep 1
    s_branch sp_16
spe_17:
    s_branch f_task
f_done2:
    s_setprio 0
    s_lshl_b32 s24, s22, 2
    s_and_b32 s25, s23, 3
    s_add_u32 s24, s24, s25
    s_lshr_b32 s25, s23, 2
    v_and_b32 v3, 31, v2
    v_lshrrev_b32 v4, 5, v2
    s_lshl_b32 s26, s25, 6
    s_lshr_b32 s27, s3, 1
    s_lshl_b32 s27, s27, 5
    s_add_u32 s26, s26, s27
    v_add_u32 v18, s26, v3
    v_lshlrev_b32 v19, 1, v4
    v_cvt_f32_u32 v19, v19
    v_and_b32 v26, 1, v3
    v_cvt_f32_u32 v26, v26
    v_fma_f32 v26, v26, -2.0, 1.0
    s_mov_b32 s32, -1
    s_mov_b32 s33, 0
    s_waitcnt vmcnt(0)
    s_mov_b64 exec, 1
    ds_add_rtn_u32 v10, v8, v9 offset:64
    s_mov_b64 exec, -1
    s_waitcnt lgkmcnt(0)
    v_readfirstlane_b32 s45, v10
    s_nop 1
    s_cmp_lg_u32 s45, 3
    s_cbranch_scc1 pube_18
    s_setprio 3
    s_mov_b32 s44, 524288
sp_19:
    ds_read_b32 v10, v8 offset:40
    s_waitcnt lgkmcnt(0)
    v_readfirstlane_b32 s45, v10
    s_sub_u32 s44, s44, 1
    s_cbranch_scc1 spe_20
    s_cmp_ge_u32 s45, 1
    s_cbranch_scc1 spe_20
    s_sleep 1
    s_branch sp_19
spe_20:
    v_mov_b32 v10, s45
    s_mov_b32 s44, 10649600
    s_mov_b64 exec, 255
    buffer_store_dword v10, v11, s[12:15], s44 offen sc1
    s_mov_b64 exec, -1
    s_setprio 0
pube_18:
    v_cvt_f32_u32 v20, v18
    v_mul_f32 v20, 0x3b000000, v20
    v_mul_f32 v21, v20, v19
    v_mul_f32 v24, 0x41000000, v20
    v_add_f32 v22, 0x3e800000, v21
    v_cos_f32 v24, v24
    v_mov_b32 v32, v21
    v_mov_b32 v33, v22
    v_fma_f32 v34, v20, 1.0, v21
    v_fma_f32 v35, v20, 1.0, v22
    v_fma_f32 v36, v20, 4.0, v21
    v_fma_f32 v37, v20, 4.0, v22
    v_fmamk_f32 v38, v20, 0x40a00000, v21
    v_fmamk_f32 v39, v20, 0x40a00000, v22
    v_cos_f32 v32, v32
    v_cos_f32 v33, v33
    v_cos_f32 v34, v34
    v_cos_f32 v35, v35
    v_cos_f32 v36, v36
    v_cos_f32 v37, v37
    v_cos_f32 v38, v38
    v_cos_f32 v39, v39
    v_cndmask_b32 v27, v33, v26, s[32:33]
    v_add_f32 v24, v24, v24
    v_cvt_pk_bf16_f32 v28, v32, v27
    v_cvt_pk_bf16_f32 v29, v34, v35
    v_cvt_pk_bf16_f32 v30, v36, v37
    v_cvt_pk_bf16_f32 v31, v38, v39
    v_accvgpr_write_b32 a0, v28
    v_accvgpr_write_b32 a1, v29
    v_accvgpr_write_b32 a2, v30
    v_accvgpr_write_b32 a3, v31
    v_fmamk_f32 v40, v20, 0x41000000, v21
    v_fmamk_f32 v41, v20, 0x41000000, v22
    v_fmamk_f32 v42, v20, 0x41100000, v21
    v_fmamk_f32 v43, v20, 0x41100000, v22
    v_fmamk_f32 v44, v20, 0x41400000, v21
    v_fmamk_f32 v45, v20, 0x41400000, v22
    v_fmamk_f32 v46, v20, 0x41500000, v21
    v_fmamk_f32 v47, v20, 0x41500000, v22
    v_cos_f32 v40, v40
    v_cos_f32 v41, v41
    v_cos_f32 v42, v42
    v_cos_f32 v43, v43
    v_cos_f32 v44, v44
    v_cos_f32 v45, v45
    v_cos_f32 v46, v46
    v_cos_f32 v47, v47
    v_cvt_pk_bf16_f32 v48, v40, v41
    v_cvt_pk_bf16_f32 v49, v42, v43
    v_cvt_pk_bf16_f32 v50, v44, v45
    v_cvt_pk_bf16_f32 v51, v46, v47
    v_accvgpr_write_b32 a4, v48
    v_accvgpr_write_b32 a5, v49
    v_accvgpr_write_b32 a6, v50
    v_accvgpr_write_b32 a7, v51
    v_fma_f32 v32, v24, v40, -v32
    v_fma_f32 v33, v24, v41, -v33
    v_fma_f32 v34, v24, v42, -v34
    v_fma_f32 v35, v24, v43, -v35
    v_fma_f32 v36, v24, v44, -v36
    v_fma_f32 v37, v24, v45, -v37
    v_fma_f32 v38, v24, v46, -v38
    v_fma_f32 v39, v24, v47, -v39
    v_cvt_pk_bf16_f32 v28, v32, v33
    v_cvt_pk_bf16_f32 v29, v34, v35
    v_cvt_pk_bf16_f32 v30, v36, v37
    v_cvt_pk_bf16_f32 v31, v38, v39
    v_accvgpr_write_b32 a8, v28
    v_accvgpr_write_b32 a9, v29
    v_accvgpr_write_b32 a10, v30
    v_accvgpr_write_b32 a11, v31
    v_fma_f32 v40, v24, v32, -v40
    v_fma_f32 v41, v24, v33, -v41
    v_fma_f32 v42, v24, v34, -v42
    v_fma_f32 v43, v24, v35, -v43
    v_fma_f32 v44, v24, v36, -v44
    v_fma_f32 v45, v24, v37, -v45
    v_fma_f32 v46, v24, v38, -v46
    v_fma_f32 v47, v24, v39, -v47
    v_cvt_pk_bf16_f32 v48, v40, v41
    v_cvt_pk_bf16_f32 v49, v42, v43
    v_cvt_pk_bf16_f32 v50, v44, v45
    v_cvt_pk_bf16_f32 v51, v46, v47
    v_accvgpr_write_b32 a12, v48
    v_accvgpr_write_b32 a13, v49
    v_accvgpr_write_b32 a14, v50
    v_accvgpr_write_b32 a15, v51
    v_fma_f32 v32, v24, v40, -v32
    v_fma_f32 v33, v24, v41, -v33
    v_fma_f32 v34, v24, v42, -v34
    v_fma_f32 v35, v24, v43, -v35
    v_fma_f32 v36, v24, v44, -v36
    v_fma_f32 v37, v24, v45, -v37
    v_fma_f32 v38, v24, v46, -v38
    v_fma_f32 v39, v24, v47, -v39
    v_cvt_pk_bf16_f32 v28, v32, v33
    v_cvt_pk_bf16_f32 v29, v34, v35
    v_cvt_pk_bf16_f32 v30, v36, v37
    v_cvt_pk_bf16_f32 v31, v38, v39
    v_accvgpr_write_b32 a16, v28
    v_accvgpr_write_b32 a17, v29
    v_accvgpr_write_b32 a18, v30
    v_accvgpr_write_b32 a19, v31
    v_fma_f32 v40, v24, v32, -v40
    v_fma_f32 v41, v24, v33, -v41
    v_fma_f32 v42, v24, v34, -v42
    v_fma_f32 v43, v24, v35, -v43
    v_fma_f32 v44, v24, v36, -v44
    v_fma_f32 v45, v24, v37, -v45
    v_fma_f32 v46, v24, v38, -v46
    v_fma_f32 v47, v24, v39, -v47
    v_cvt_pk_bf16_f32 v48, v40, v41
    v_cvt_pk_bf16_f32 v49, v42, v43
    v_cvt_pk_bf16_f32 v50, v44, v45
    v_cvt_pk_bf16_f32 v51, v46, v47
    v_accvgpr_write_b32 a20, v48
    v_accvgpr_write_b32 a21, v49
    v_accvgpr_write_b32 a22, v50
    v_accvgpr_write_b32 a23, v51
    v_fma_f32 v32, v24, v40, -v32
    v_fma_f32 v33, v24, v41, -v33
    v_fma_f32 v34, v24, v42, -v34
    v_fma_f32 v35, v24, v43, -v35
    v_fma_f32 v36, v24, v44, -v36
    v_fma_f32 v37, v24, v45, -v37
    v_fma_f32 v38, v24, v46, -v38
    v_fma_f32 v39, v24, v47, -v39
    v_cvt_pk_bf16_f32 v28, v32, v33
    v_cvt_pk_bf16_f32 v29, v34, v35
    v_cvt_pk_bf16_f32 v30, v36, v37
    v_cvt_pk_bf16_f32 v31, v38, v39
    v_accvgpr_write_b32 a24, v28
    v_accvgpr_write_b32 a25, v29
    v_accvgpr_write_b32 a26, v30
    v_accvgpr_write_b32 a27, v31
    v_fma_f32 v40, v24, v32, -v40
    v_fma_f32 v41, v24, v33, -v41
    v_fma_f32 v42, v24, v34, -v42
    v_fma_f32 v43, v24, v35, -v43
    v_fma_f32 v44, v24, v36, -v44
    v_fma_f32 v45, v24, v37, -v45
    v_fma_f32 v46, v24, v38, -v46
    v_fma_f32 v47, v24, v39, -v47
    v_cvt_pk_bf16_f32 v48, v40, v41
    v_cvt_pk_bf16_f32 v49, v42, v43
    v_cvt_pk_bf16_f32 v50, v44, v45
    v_cvt_pk_bf16_f32 v51, v46, v47
    v_accvgpr_write_b32 a28, v48
    v_accvgpr_write_b32 a29, v49
    v_accvgpr_write_b32 a30, v50
    v_accvgpr_write_b32 a31, v51
    v_fma_f32 v32, v24, v40, -v32
    v_fma_f32 v33, v24, v41, -v33
    v_fma_f32 v34, v24, v42, -v34
    v_fma_f32 v35, v24, v43, -v35
    v_fma_f32 v36, v24, v44, -v36
    v_fma_f32 v37, v24, v45, -v37
    v_fma_f32 v38, v24, v46, -v38
    v_fma_f32 v39, v24, v47, -v39
    v_cvt_pk_bf16_f32 v28, v32, v33
    v_cvt_pk_bf16_f32 v29, v34, v35
    v_cvt_pk_bf16_f32 v30, v36, v37
    v_cvt_pk_bf16_f32 v31, v38, v39
    v_accvgpr_write_b32 a32, v28
    v_accvgpr_write_b32 a33, v29
    v_accvgpr_write_b32 a34, v30
    v_accvgpr_write_b32 a35, v31
    v_fma_f32 v40, v24, v32, -v40
    v_fma_f32 v41, v24, v33, -v41
    v_fma_f32 v42, v24, v34, -v42
    v_fma_f32 v43, v24, v35, -v43
    v_fma_f32 v44, v24, v36, -v44
    v_fma_f32 v45, v24, v37, -v45
    v_fma_f32 v46, v24, v38, -v46
    v_fma_f32 v47, v24, v39, -v47
    v_cvt_pk_bf16_f32 v48, v40, v41
    v_cvt_pk_bf16_f32 v49, v42, v43
    v_cvt_pk_bf16_f32 v50, v44, v45
    v_cvt_pk_bf16_f32 v51, v46, v47
    v_accvgpr_write_b32 a36, v48
    v_accvgpr_write_b32 a37, v49
    v_accvgpr_write_b32 a38, v50
    v_accvgpr_write_b32 a39, v51
    v_fma_f32 v32, v24, v40, -v32
    v_fma_f32 v33, v24, v41, -v33
    v_fma_f32 v34, v24, v42, -v34
    v_fma_f32 v35, v24, v43, -v35
    v_fma_f32 v36, v24, v44, -v36
    v_fma_f32 v37, v24, v45, -v37
    v_fma_f32 v38, v24, v46, -v38
    v_fma_f32 v39, v24, v47, -v39
    v_cvt_pk_bf16_f32 v28, v32, v33
    v_cvt_pk_bf16_f32 v29, v34, v35
    v_cvt_pk_bf16_f32 v30, v36, v37
    v_cvt_pk_bf16_f32 v31, v38, v39
    v_accvgpr_write_b32 a40, v28
    v_accvgpr_write_b32 a41, v29
    v_accvgpr_write_b32 a42, v30
    v_accvgpr_write_b32 a43, v31
    v_fma_f32 v40, v24, v32, -v40
    v_fma_f32 v41, v24, v33, -v41
    v_fma_f32 v42, v24, v34, -v42
    v_fma_f32 v43, v24, v35, -v43
    v_fma_f32 v44, v24, v36, -v44
    v_fma_f32 v45, v24, v37, -v45
    v_fma_f32 v46, v24, v38, -v46
    v_fma_f32 v47, v24, v39, -v47
    v_cvt_pk_bf16_f32 v48, v40, v41
    v_cvt_pk_bf16_f32 v49, v42, v43
    v_cvt_pk_bf16_f32 v50, v44, v45
    v_cvt_pk_bf16_f32 v51, v46, v47
    v_accvgpr_write_b32 a44, v48
    v_accvgpr_write_b32 a45, v49
    v_accvgpr_write_b32 a46, v50
    v_accvgpr_write_b32 a47, v51
    v_fma_f32 v32, v24, v40, -v32
    v_fma_f32 v33, v24, v41, -v33
    v_fma_f32 v34, v24, v42, -v34
    v_fma_f32 v35, v24, v43, -v35
    v_fma_f32 v36, v24, v44, -v36
    v_fma_f32 v37, v24, v45, -v37
    v_fma_f32 v38, v24, v46, -v38
    v_fma_f32 v39, v24, v47, -v39
    v_cvt_pk_bf16_f32 v28, v32, v33
    v_cvt_pk_bf16_f32 v29, v34, v35
    v_cvt_pk_bf16_f32 v30, v36, v37
    v_cvt_pk_bf16_f32 v31, v38, v39
    v_accvgpr_write_b32 a48, v28
    v_accvgpr_write_b32 a49, v29
    v_accvgpr_write_b32 a50, v30
    v_accvgpr_write_b32 a51, v31
    v_fma_f32 v40, v24, v32, -v40
    v_fma_f32 v41, v24, v33, -v41
    v_fma_f32 v42, v24, v34, -v42
    v_fma_f32 v43, v24, v35, -v43
    v_fma_f32 v44, v24, v36, -v44
    v_fma_f32 v45, v24, v37, -v45
    v_fma_f32 v46, v24, v38, -v46
    v_fma_f32 v47, v24, v39, -v47
    v_cvt_pk_bf16_f32 v48, v40, v41
    v_cvt_pk_bf16_f32 v49, v42, v43
    v_cvt_pk_bf16_f32 v50, v44, v45
    v_cvt_pk_bf16_f32 v51, v46, v47
    v_accvgpr_write_b32 a52, v48
    v_accvgpr_write_b32 a53, v49
    v_accvgpr_write_b32 a54, v50
    v_accvgpr_write_b32 a55, v51
    v_fma_f32 v32, v24, v40, -v32
    v_fma_f32 v33, v24, v41, -v33
    v_fma_f32 v34, v24, v42, -v34
    v_fma_f32 v35, v24, v43, -v35
    v_fma_f32 v36, v24, v44, -v36
    v_fma_f32 v37, v24, v45, -v37
    v_fma_f32 v38, v24, v46, -v38
    v_fma_f32 v39, v24, v47, -v39
    v_cvt_pk_bf16_f32 v28, v32, v33
    v_cvt_pk_bf16_f32 v29, v34, v35
    v_cvt_pk_bf16_f32 v30, v36, v37
    v_cvt_pk_bf16_f32 v31, v38, v39
    v_accvgpr_write_b32 a56, v28
    v_accvgpr_write_b32 a57, v29
    v_accvgpr_write_b32 a58, v30
    v_accvgpr_write_b32 a59, v31
    v_fma_f32 v40, v24, v32, -v40
    v_fma_f32 v41, v24, v33, -v41
    v_fma_f32 v42, v24, v34, -v42
    v_fma_f32 v43, v24, v35, -v43
    v_fma_f32 v44, v24, v36, -v44
    v_fma_f32 v45, v24, v37, -v45
    v_fma_f32 v46, v24, v38, -v46
    v_fma_f32 v47, v24, v39, -v47
    v_cvt_pk_bf16_f32 v48, v40, v41
    v_cvt_pk_bf16_f32 v49, v42, v43
    v_cvt_pk_bf16_f32 v50, v44, v45
    v_cvt_pk_bf16_f32 v51, v46, v47
    v_accvgpr_write_b32 a60, v48
    v_accvgpr_write_b32 a61, v49
    v_accvgpr_write_b32 a62, v50
    v_accvgpr_write_b32 a63, v51
    v_fmamk_f32 v32, v20, 0x43000000, v21
    v_fmamk_f32 v33, v20, 0x43000000, v22
    v_fmamk_f32 v34, v20, 0x43010000, v21
    v_fmamk_f32 v35, v20, 0x43010000, v22
    v_fmamk_f32 v36, v20, 0x43040000, v21
    v_fmamk_f32 v37, v20, 0x43040000, v22
    v_fmamk_f32 v38, v20, 0x43050000, v21
    v_fmamk_f32 v39, v20, 0x43050000, v22
    v_cos_f32 v32, v32
    v_cos_f32 v33, v33
    v_cos_f32 v34, v34
    v_cos_f32 v35, v35
    v_cos_f32 v36, v36
    v_cos_f32 v37, v37
    v_cos_f32 v38, v38
    v_cos_f32 v39, v39
    v_cvt_pk_bf16_f32 v28, v32, v33
    v_cvt_pk_bf16_f32 v29, v34, v35
    v_cvt_pk_bf16_f32 v30, v36, v37
    v_cvt_pk_bf16_f32 v31, v38, v39
    v_accvgpr_write_b32 a64, v28
    v_accvgpr_write_b32 a65, v29
    v_accvgpr_write_b32 a66, v30
    v_accvgpr_write_b32 a67, v31
    v_fmamk_f32 v40, v20, 0x43080000, v21
    v_fmamk_f32 v41, v20, 0x43080000, v22
    v_fmamk_f32 v42, v20, 0x43090000, v21
    v_fmamk_f32 v43, v20, 0x43090000, v22
    v_fmamk_f32 v44, v20, 0x430c0000, v21
    v_fmamk_f32 v45, v20, 0x430c0000, v22
    v_fmamk_f32 v46, v20, 0x430d0000, v21
    v_fmamk_f32 v47, v20, 0x430d0000, v22
    v_cos_f32 v40, v40
    v_cos_f32 v41, v41
    v_cos_f32 v42, v42
    v_cos_f32 v43, v43
    v_cos_f32 v44, v44
    v_cos_f32 v45, v45
    v_cos_f32 v46, v46
    v_cos_f32 v47, v47
    v_cvt_pk_bf16_f32 v48, v40, v41
    v_cvt_pk_bf16_f32 v49, v42, v43
    v_cvt_pk_bf16_f32 v50, v44, v45
    v_cvt_pk_bf16_f32 v51, v46, v47
    v_accvgpr_write_b32 a68, v48
    v_accvgpr_write_b32 a69, v49
    v_accvgpr_write_b32 a70, v50
    v_accvgpr_write_b32 a71, v51
    v_fma_f32 v32, v24, v40, -v32
    v_fma_f32 v33, v24, v41, -v33
    v_fma_f32 v34, v24, v42, -v34
    v_fma_f32 v35, v24, v43, -v35
    v_fma_f32 v36, v24, v44, -v36
    v_fma_f32 v37, v24, v45, -v37
    v_fma_f32 v38, v24, v46, -v38
    v_fma_f32 v39, v24, v47, -v39
    v_cvt_pk_bf16_f32 v28, v32, v33
    v_cvt_pk_bf16_f32 v29, v34, v35
    v_cvt_pk_bf16_f32 v30, v36, v37
    v_cvt_pk_bf16_f32 v31, v38, v39
    v_accvgpr_write_b32 a72, v28
    v_accvgpr_write_b32 a73, v29
    v_accvgpr_write_b32 a74, v30
    v_accvgpr_write_b32 a75, v31
    v_fma_f32 v40, v24, v32, -v40
    v_fma_f32 v41, v24, v33, -v41
    v_fma_f32 v42, v24, v34, -v42
    v_fma_f32 v43, v24, v35, -v43
    v_fma_f32 v44, v24, v36, -v44
    v_fma_f32 v45, v24, v37, -v45
    v_fma_f32 v46, v24, v38, -v46
    v_fma_f32 v47, v24, v39, -v47
    v_cvt_pk_bf16_f32 v48, v40, v41
    v_cvt_pk_bf16_f32 v49, v42, v43
    v_cvt_pk_bf16_f32 v50, v44, v45
    v_cvt_pk_bf16_f32 v51, v46, v47
    v_accvgpr_write_b32 a76, v48
    v_accvgpr_write_b32 a77, v49
    v_accvgpr_write_b32 a78, v50
    v_accvgpr_write_b32 a79, v51
    v_fma_f32 v32, v24, v40, -v32
    v_fma_f32 v33, v24, v41, -v33
    v_fma_f32 v34, v24, v42, -v34
    v_fma_f32 v35, v24, v43, -v35
    v_fma_f32 v36, v24, v44, -v36
    v_fma_f32 v37, v24, v45, -v37
    v_fma_f32 v38, v24, v46, -v38
    v_fma_f32 v39, v24, v47, -v39
    v_cvt_pk_bf16_f32 v28, v32, v33
    v_cvt_pk_bf16_f32 v29, v34, v35
    v_cvt_pk_bf16_f32 v30, v36, v37
    v_cvt_pk_bf16_f32 v31, v38, v39
    v_accvgpr_write_b32 a80, v28
    v_accvgpr_write_b32 a81, v29
    v_accvgpr_write_b32 a82, v30
    v_accvgpr_write_b32 a83, v31
    v_fma_f32 v40, v24, v32, -v40
    v_fma_f32 v41, v24, v33, -v41
    v_fma_f32 v42, v24, v34, -v42
    v_fma_f32 v43, v24, v35, -v43
    v_fma_f32 v44, v24, v36, -v44
    v_fma_f32 v45, v24, v37, -v45
    v_fma_f32 v46, v24, v38, -v46
    v_fma_f32 v47, v24, v39, -v47
    v_cvt_pk_bf16_f32 v48, v40, v41
    v_cvt_pk_bf16_f32 v49, v42, v43
    v_cvt_pk_bf16_f32 v50, v44, v45
    v_cvt_pk_bf16_f32 v51, v46, v47
    v_accvgpr_write_b32 a84, v48
    v_accvgpr_write_b32 a85, v49
    v_accvgpr_write_b32 a86, v50
    v_accvgpr_write_b32 a87, v51
    v_fma_f32 v32, v24, v40, -v32
    v_fma_f32 v33, v24, v41, -v33
    v_fma_f32 v34, v24, v42, -v34
    v_fma_f32 v35, v24, v43, -v35
    v_fma_f32 v36, v24, v44, -v36
    v_fma_f32 v37, v24, v45, -v37
    v_fma_f32 v38, v24, v46, -v38
    v_fma_f32 v39, v24, v47, -v39
    v_cvt_pk_bf16_f32 v28, v32, v33
    v_cvt_pk_bf16_f32 v29, v34, v35
    v_cvt_pk_bf16_f32 v30, v36, v37
    v_cvt_pk_bf16_f32 v31, v38, v39
    v_accvgpr_write_b32 a88, v28
    v_accvgpr_write_b32 a89, v29
    v_accvgpr_write_b32 a90, v30
    v_accvgpr_write_b32 a91, v31
    v_fma_f32 v40, v24, v32, -v40
    v_fma_f32 v41, v24, v33, -v41
    v_fma_f32 v42, v24, v34, -v42
    v_fma_f32 v43, v24, v35, -v43
    v_fma_f32 v44, v24, v36, -v44
    v_fma_f32 v45, v24, v37, -v45
    v_fma_f32 v46, v24, v38, -v46
    v_fma_f32 v47, v24, v39, -v47
    v_cvt_pk_bf16_f32 v48, v40, v41
    v_cvt_pk_bf16_f32 v49, v42, v43
    v_cvt_pk_bf16_f32 v50, v44, v45
    v_cvt_pk_bf16_f32 v51, v46, v47
    v_accvgpr_write_b32 a92, v48
    v_accvgpr_write_b32 a93, v49
    v_accvgpr_write_b32 a94, v50
    v_accvgpr_write_b32 a95, v51
    v_fma_f32 v32, v24, v40, -v32
    v_fma_f32 v33, v24, v41, -v33
    v_fma_f32 v34, v24, v42, -v34
    v_fma_f32 v35, v24, v43, -v35
    v_fma_f32 v36, v24, v44, -v36
    v_fma_f32 v37, v24, v45, -v37
    v_fma_f32 v38, v24, v46, -v38
    v_fma_f32 v39, v24, v47, -v39
    v_cvt_pk_bf16_f32 v28, v32, v33
    v_cvt_pk_bf16_f32 v29, v34, v35
    v_cvt_pk_bf16_f32 v30, v36, v37
    v_cvt_pk_bf16_f32 v31, v38, v39
    v_accvgpr_write_b32 a96, v28
    v_accvgpr_write_b32 a97, v29
    v_accvgpr_write_b32 a98, v30
    v_accvgpr_write_b32 a99, v31
    v_fma_f32 v40, v24, v32, -v40
    v_fma_f32 v41, v24, v33, -v41
    v_fma_f32 v42, v24, v34, -v42
    v_fma_f32 v43, v24, v35, -v43
    v_fma_f32 v44, v24, v36, -v44
    v_fma_f32 v45, v24, v37, -v45
    v_fma_f32 v46, v24, v38, -v46
    v_fma_f32 v47, v24, v39, -v47
    v_cvt_pk_bf16_f32 v48, v40, v41
    v_cvt_pk_bf16_f32 v49, v42, v43
    v_cvt_pk_bf16_f32 v50, v44, v45
    v_cvt_pk_bf16_f32 v51, v46, v47
    v_accvgpr_write_b32 a100, v48
    v_accvgpr_write_b32 a101, v49
    v_accvgpr_write_b32 a102, v50
    v_accvgpr_write_b32 a103, v51
    v_fma_f32 v32, v24, v40, -v32
    v_fma_f32 v33, v24, v41, -v33
    v_fma_f32 v34, v24, v42, -v34
    v_fma_f32 v35, v24, v43, -v35
    v_fma_f32 v36, v24, v44, -v36
    v_fma_f32 v37, v24, v45, -v37
    v_fma_f32 v38, v24, v46, -v38
    v_fma_f32 v39, v24, v47, -v39
    v_cvt_pk_bf16_f32 v28, v32, v33
    v_cvt_pk_bf16_f32 v29, v34, v35
    v_cvt_pk_bf16_f32 v30, v36, v37
    v_cvt_pk_bf16_f32 v31, v38, v39
    v_accvgpr_write_b32 a104, v28
    v_accvgpr_write_b32 a105, v29
    v_accvgpr_write_b32 a106, v30
    v_accvgpr_write_b32 a107, v31
    v_fma_f32 v40, v24, v32, -v40
    v_fma_f32 v41, v24, v33, -v41
    v_fma_f32 v42, v24, v34, -v42
    v_fma_f32 v43, v24, v35, -v43
    v_fma_f32 v44, v24, v36, -v44
    v_fma_f32 v45, v24, v37, -v45
    v_fma_f32 v46, v24, v38, -v46
    v_fma_f32 v47, v24, v39, -v47
    v_cvt_pk_bf16_f32 v48, v40, v41
    v_cvt_pk_bf16_f32 v49, v42, v43
    v_cvt_pk_bf16_f32 v50, v44, v45
    v_cvt_pk_bf16_f32 v51, v46, v47
    v_accvgpr_write_b32 a108, v48
    v_accvgpr_write_b32 a109, v49
    v_accvgpr_write_b32 a110, v50
    v_accvgpr_write_b32 a111, v51
    v_fma_f32 v32, v24, v40, -v32
    v_fma_f32 v33, v24, v41, -v33
    v_fma_f32 v34, v24, v42, -v34
    v_fma_f32 v35, v24, v43, -v35
    v_fma_f32 v36, v24, v44, -v36
    v_fma_f32 v37, v24, v45, -v37
    v_fma_f32 v38, v24, v46, -v38
    v_fma_f32 v39, v24, v47, -v39
    v_cvt_pk_bf16_f32 v28, v32, v33
    v_cvt_pk_bf16_f32 v29, v34, v35
    v_cvt_pk_bf16_f32 v30, v36, v37
    v_cvt_pk_bf16_f32 v31, v38, v39
    v_accvgpr_write_b32 a112, v28
    v_accvgpr_write_b32 a113, v29
    v_accvgpr_write_b32 a114, v30
    v_accvgpr_write_b32 a115, v31
    v_fma_f32 v40, v24, v32, -v40
    v_fma_f32 v41, v24, v33, -v41
    v_fma_f32 v42, v24, v34, -v42
    v_fma_f32 v43, v24, v35, -v43
    v_fma_f32 v44, v24, v36, -v44
    v_fma_f32 v45, v24, v37, -v45
    v_fma_f32 v46, v24, v38, -v46
    v_fma_f32 v47, v24, v39, -v47
    v_cvt_pk_bf16_f32 v48, v40, v41
    v_cvt_pk_bf16_f32 v49, v42, v43
    v_cvt_pk_bf16_f32 v50, v44, v45
    v_cvt_pk_bf16_f32 v51, v46, v47
    v_accvgpr_write_b32 a116, v48
    v_accvgpr_write_b32 a117, v49
    v_accvgpr_write_b32 a118, v50
    v_accvgpr_write_b32 a119, v51
    v_fma_f32 v32, v24, v40, -v32
    v_fma_f32 v33, v24, v41, -v33
    v_fma_f32 v34, v24, v42, -v34
    v_fma_f32 v35, v24, v43, -v35
    v_fma_f32 v36, v24, v44, -v36
    v_fma_f32 v37, v24, v45, -v37
    v_fma_f32 v38, v24, v46, -v38
    v_fma_f32 v39, v24, v47, -v39
    v_cvt_pk_bf16_f32 v28, v32, v33
    v_cvt_pk_bf16_f32 v29, v34, v35
    v_cvt_pk_bf16_f32 v30, v36, v37
    v_cvt_pk_bf16_f32 v31, v38, v39
    v_accvgpr_write_b32 a120, v28
    v_accvgpr_write_b32 a121, v29
    v_accvgpr_write_b32 a122, v30
    v_accvgpr_write_b32 a123, v31
    v_fma_f32 v40, v24, v32, -v40
    v_fma_f32 v41, v24, v33, -v41
    v_fma_f32 v42, v24, v34, -v42
    v_fma_f32 v43, v24, v35, -v43
    v_fma_f32 v44, v24, v36, -v44
    v_fma_f32 v45, v24, v37, -v45
    v_fma_f32 v46, v24, v38, -v46
    v_fma_f32 v47, v24, v39, -v47
    v_cvt_pk_bf16_f32 v48, v40, v41
    v_cvt_pk_bf16_f32 v49, v42, v43
    v_cvt_pk_bf16_f32 v50, v44, v45
    v_cvt_pk_bf16_f32 v51, v46, v47
    v_accvgpr_write_b32 a124, v48
    v_accvgpr_write_b32 a125, v49
    v_accvgpr_write_b32 a126, v50
    v_accvgpr_write_b32 a127, v51
    v_lshrrev_b32 v13, 3, v2
    v_bfe_u32 v14, v2, 4, 1
    v_lshlrev_b32 v14, 2, v14
    v_xor_b32 v14, v14, v2
    v_and_b32 v14, 7, v14
    v_lshlrev_b32 v14, 4, v14
    v_lshl_add_u32 v15, v13, 7, v14
    s_mul_i32 s42, s3, 6144
    s_add_u32 s42, s42, 131072
    s_mov_b32 s26, 131072
    v_bfe_u32 v13, v2, 2, 2
    v_lshrrev_b32 v14, 5, v2
    v_lshl_add_u32 v16, v14, 2, v13
    v_lshlrev_b32 v16, 7, v16
    v_lshrrev_b32 v13, 1, v13
    v_lshl_add_u32 v16, v13, 6, v16
    v_bfe_u32 v13, v2, 4, 1
    v_lshl_add_u32 v16, v13, 5, v16
    v_and_b32 v13, 3, v2
    v_lshl_add_u32 v16, v13, 3, v16
    v_add_u32 v16, s26, v16
    s_and_b32 s26, s3, 1
    s_lshl_b32 s26, s26, 6
    v_xor_b32 v16, s26, v16
    s_lshl_b32 s41, s24, 16
    s_lshl_b32 s26, s3, 14
    s_add_u32 s41, s41, s26
    s_add_u32 s41, s41, 14680064
    s_lshl_b32 s26, s3, 15
    v_add_u32 v18, s26, v5
    s_cmp_ge_u32 s23, 28
    s_cselect_b32 s27, 0, 1
    s_mov_b32 s44, 524288
sp_21:
    ds_read_b32 v10, v8 offset:56
    s_waitcnt lgkmcnt(0)
    v_readfirstlane_b32 s45, v10
    s_sub_u32 s44, s44, 1
    s_cbranch_scc1 spe_22
    s_cmp_ge_u32 s45, s27
    s_cbranch_scc1 spe_22
    s_sleep 1
    s_branch sp_21
spe_22:
    s_xor_b32 s27, s27, 1
    s_lshl_b32 s27, s27, 2
    s_mov_b32 s44, 524288
sp_23:
    ds_read_b32 v10, v8 offset:80
    s_waitcnt lgkmcnt(0)
    v_readfirstlane_b32 s45, v10
    s_sub_u32 s44, s44, 1
    s_cbranch_scc1 spe_24
    s_cmp_ge_u32 s45, s27
    s_cbranch_scc1 spe_24
    s_sleep 1
    s_branch sp_23
spe_24:
    s_cmp_lg_u32 s3, 1
    s_cbranch_scc1 f_wait2a
    s_lshl_b32 s26, s25, 7
    s_setprio 3
    s_mov_b32 s44, 524288
sp_27:
    ds_read_b32 v10, v8 offset:40
    s_waitcnt lgkmcnt(0)
    v_readfirstlane_b32 s45, v10
    s_sub_u32 s44, s44, 1
    s_cbranch_scc1 spe_28
    s_cmp_ge_u32 s45, 1
    s_cbranch_scc1 spe_28
    s_sleep 1
    s_branch sp_27
spe_28:
    s_mov_b32 s46, s45
    s_lshl_b32 s47, s22, 12
    s_add_u32 s47, s47, 10616832
    s_add_u32 s47, s47, s26
    s_mov_b32 s44, 65536
    s_mov_b64 exec, 0x7f
pl_25:
    buffer_load_dwordx4 v[32:35], v12, s[12:15], s47 offen sc1
    s_waitcnt vmcnt(0)
    v_xor_b32 v32, s46, v32
    v_xor_b32 v33, s46, v33
    v_xor_b32 v34, s46, v34
    v_xor_b32 v35, s46, v35
    v_or_b32 v32, v32, v33
    v_or3_b32 v32, v32, v34, v35
    v_cmp_ne_u32 vcc, 0, v32
    s_sub_u32 s44, s44, 1
    s_cbranch_scc1 ple_26
    s_cbranch_vccz ple_26
    s_sleep 2
    s_branch pl_25
ple_26:
    s_mov_b64 exec, 1
    ds_write_b32 v8, v9 offset:24
    s_mov_b64 exec, -1
    s_setprio 0
f_wait2a:
    s_cmp_lg_u32 s3, 0
    s_cbranch_scc1 f_wait2
    s_setprio 3
    s_mov_b32 s44, 524288
sp_31:
    ds_read_b32 v10, v8 offset:40
    s_waitcnt lgkmcnt(0)
    v_readfirstlane_b32 s45, v10
    s_sub_u32 s44, s44, 1
    s_cbranch_scc1 spe_32
    s_cmp_ge_u32 s45, 1
    s_cbranch_scc1 spe_32
    s_sleep 1
    s_branch sp_31
spe_32:
    s_mov_b32 s46, s45
    s_lshl_b32 s47, s22, 12
    s_add_u32 s47, s47, 10649600
    s_mov_b32 s44, 65536
pl_29:
    buffer_load_dwordx4 v[32:35], v12, s[12:15], s47 offen sc1
    s_waitcnt vmcnt(0)
    v_xor_b32 v32, s46, v32
    v_xor_b32 v33, s46, v33
    v_xor_b32 v34, s46, v34
    v_xor_b32 v35, s46, v35
    v_or_b32 v32, v32, v33
    v_or3_b32 v32, v32, v34, v35
    v_cmp_ne_u32 vcc, 0, v32
    s_sub_u32 s44, s44, 1
    s_cbranch_scc1 ple_30
    s_cbranch_vccz ple_30
    s_sleep 2
    s_branch pl_29
ple_30:
    s_mov_b64 exec, 1
    ds_write_b32 v8, v9 offset:68
    s_mov_b64 exec, -1
    s_setprio 0
f_wait2:
    s_mov_b32 s44, 524288
sp_33:
    ds_read_b32 v10, v8 offset:68
    s_waitcnt lgkmcnt(0)
    v_readfirstlane_b32 s45, v10
    s_sub_u32 s44, s44, 1
    s_cbranch_scc1 spe_34
    s_cmp_ge_u32 s45, 1
    s_cbranch_scc1 spe_34
    s_sleep 1
    s_branch sp_33
spe_34:
    s_setprio 3
    s_add_u32 s43, s41, 0
    buffer_load_dwordx4 v[64:67], v15, s[12:15], s43 offen offset:0 sc1
    buffer_load_dwordx4 v[68:71], v15, s[12:15], s43 offen offset:1024 sc1
    s_add_u32 s43, s41, 2048
    buffer_load_dwordx4 v[72:75], v15, s[12:15], s43 offen offset:0 sc1
    buffer_load_dwordx4 v[76:79], v15, s[12:15], s43 offen offset:1024 sc1
    s_add_u32 s43, s41, 4096
    buffer_load_dwordx4 v[80:83], v15, s[12:15], s43 offen offset:0 sc1
    buffer_load_dwordx4 v[84:87], v15, s[12:15], s43 offen offset:1024 sc1
    s_add_u32 s43, s41, 6144
    buffer_load_dwordx4 v[88:91], v15, s[12:15], s43 offen offset:0 sc1
    buffer_load_dwordx4 v[92:95], v15, s[12:15], s43 offen offset:1024 sc1
    s_add_u32 s43, s41, 8192
    buffer_load_dwordx4 v[96:99], v15, s[12:15], s43 offen offset:0 sc1
    buffer_load_dwordx4 v[100:103], v15, s[12:15], s43 offen offset:1024 sc1
    s_add_u32 s43, s41, 10240
    buffer_load_dwordx4 v[104:107], v15, s[12:15], s43 offen offset:0 sc1
    buffer_load_dwordx4 v[108:111], v15, s[12:15], s43 offen offset:1024 sc1
    s_add_u32 s43, s41, 12288
    buffer_load_dwordx4 v[112:115], v15, s[12:15], s43 offen offset:0 sc1
    buffer_load_dwordx4 v[116:119], v15, s[12:15], s43 offen offset:1024 sc1
    s_add_u32 s43, s41, 14336
    buffer_load_dwordx4 v[120:123], v15, s[12:15], s43 offen offset:0 sc1
    buffer_load_dwordx4 v[124:127], v15, s[12:15], s43 offen offset:1024 sc1
    v_add_u32 v19, s42, v5
    s_lshl_b32 s26, s3, 12
    s_add_u32 s26, s26, 131072
    v_add_u32 v18, s26, v5
    s_waitcnt vmcnt(14)
    ds_write_b128 v19, v[64:67] offset:0
    ds_write_b128 v19, v[68:71] offset:1024
    s_waitcnt vmcnt(12)
    ds_write_b128 v19, v[72:75] offset:2048
    ds_write_b128 v19, v[76:79] offset:3072
    s_waitcnt vmcnt(10)
    ds_write_b128 v19, v[80:83] offset:4096
    ds_write_b128 v19, v[84:87] offset:5120
    s_waitcnt lgkmcnt(0)
    s_mov_b64 exec, 1
    ds_add_u32 v8, v9 offset:88
    s_mov_b64 exec, -1
    s_mov_b32 s44, 524288
sp_35:
    ds_read_b32 v10, v8 offset:88
    s_waitcnt lgkmcnt(0)
    v_readfirstlane_b32 s45, v10
    s_sub_u32 s44, s44, 1
    s_cbranch_scc1 spe_36
    s_cmp_ge_u32 s45, 4
    s_cbranch_scc1 spe_36
    s_sleep 0
    s_branch sp_35
spe_36:
    ds_read_b64_tr_b16 v[32:33], v16 offset:0
    ds_read_b64_tr_b16 v[34:35], v16 offset:1024
    ds_read_b64_tr_b16 v[36:37], v16 offset:2048
    ds_read_b64_tr_b16 v[38:39], v16 offset:3072
    ds_read_b64_tr_b16 v[40:41], v16 offset:4096
    ds_read_b64_tr_b16 v[42:43], v16 offset:5120
    ds_read_b64_tr_b16 v[44:45], v16 offset:6144
    ds_read_b64_tr_b16 v[46:47], v16 offset:7168
    s_waitcnt lgkmcnt(6)
    v_mfma_f32_32x32x16_bf16 v[48:63], a[0:3], v[32:35], 0
    ds_read_b64_tr_b16 v[32:33], v16 offset:8192
    ds_read_b64_tr_b16 v[34:35], v16 offset:9216
    s_waitcnt lgkmcnt(6)
    v_mfma_f32_32x32x16_bf16 v[48:63], a[4:7], v[36:39], v[48:63]
    ds_read_b64_tr_b16 v[36:37], v16 offset:10240
    ds_read_b64_tr_b16 v[38:39], v16 offset:11264
    s_waitcnt lgkmcnt(6)
    v_mfma_f32_32x32x16_bf16 v[48:63], a[8:11], v[40:43], v[48:63]
    ds_read_b64_tr_b16 v[40:41], v16 offset:12288
    ds_read_b64_tr_b16 v[42:43], v16 offset:13312
    s_waitcnt lgkmcnt(6)
    v_mfma_f32_32x32x16_bf16 v[48:63], a[32:35], v[44:47], v[48:63]
    ds_read_b64_tr_b16 v[44:45], v16 offset:14336
    ds_read_b64_tr_b16 v[46:47], v16 offset:15360
    s_waitcnt lgkmcnt(6)
    v_mfma_f32_32x32x16_bf16 v[48:63], a[36:39], v[32:35], v[48:63]
    ds_read_b64_tr_b16 v[32:33], v16 offset:16384
    ds_read_b64_tr_b16 v[34:35], v16 offset:17408
    s_waitcnt lgkmcnt(6)
    v_mfma_f32_32x32x16_bf16 v[48:63], a[40:43], v[36:39], v[48:63]
    ds_read_b64_tr_b16 v[36:37], v16 offset:18432
    ds_read_b64_tr_b16 v[38:39], v16 offset:19456
    s_waitcnt lgkmcnt(6)
    v_mfma_f32_32x32x16_bf16 v[48:63], a[64:67], v[40:43], v[48:63]
    ds_read_b64_tr_b16 v[40:41], v16 offset:20480
    ds_read_b64_tr_b16 v[42:43], v16 offset:21504
    s_waitcnt lgkmcnt(6)
    v_mfma_f32_32x32x16_bf16 v[48:63], a[68:71], v[44:47], v[48:63]
    ds_read_b64_tr_b16 v[44:45], v16 offset:22528
    ds_read_b64_tr_b16 v[46:47], v16 offset:23552
    s_waitcnt lgkmcnt(6)
    v_mfma_f32_32x32x16_bf16 v[48:63], a[72:75], v[32:35], v[48:63]
    s_waitcnt lgkmcnt(4)
    v_mfma_f32_32x32x16_bf16 v[48:63], a[96:99], v[36:39], v[48:63]
    s_waitcnt lgkmcnt(2)
    v_mfma_f32_32x32x16_bf16 v[48:63], a[100:103], v[40:43], v[48:63]
    s_waitcnt lgkmcnt(0)
    s_mov_b64 exec, 1
    ds_add_u32 v8, v9 offset:92
    s_mov_b64 exec, -1
    v_mfma_f32_32x32x16_bf16 v[48:63], a[104:107], v[44:47], v[48:63]
    s_mov_b32 s44, 524288
sp_37:
    ds_read_b32 v10, v8 offset:92
    s_waitcnt lgkmcnt(0)
    v_readfirstlane_b32 s45, v10
    s_sub_u32 s44, s44, 1
    s_cbranch_scc1 spe_38
    s_cmp_ge_u32 s45, 4
    s_cbranch_scc1 spe_38
    s_sleep 0
    s_branch sp_37
spe_38:
    s_waitcnt vmcnt(8)
    ds_write_b128 v19, v[88:91] offset:0
    ds_write_b128 v19, v[92:95] offset:1024
    s_waitcnt vmcnt(6)
    ds_write_b128 v19, v[96:99] offset:2048
    ds_write_b128 v19, v[100:103] offset:3072
    s_waitcnt vmcnt(4)
    ds_write_b128 v19, v[104:107] offset:4096
    ds_write_b128 v19, v[108:111] offset:5120
    s_waitcnt lgkmcnt(0)
    s_mov_b64 exec, 1
    ds_add_u32 v8, v9 offset:88
    s_mov_b64 exec, -1
    s_mov_b32 s44, 524288
sp_39:
    ds_read_b32 v10, v8 offset:88
    s_waitcnt lgkmcnt(0)
    v_readfirstlane_b32 s45, v10
    s_sub_u32 s44, s44, 1
    s_cbranch_scc1 spe_40
    s_cmp_ge_u32 s45, 8
    s_cbranch_scc1 spe_40
    s_sleep 0
    s_branch sp_39
spe_40:
    ds_read_b64_tr_b16 v[32:33], v16 offset:0
    ds_read_b64_tr_b16 v[34:35], v16 offset:1024
    ds_read_b64_tr_b16 v[36:37], v16 offset:2048
    ds_read_b64_tr_b16 v[38:39], v16 offset:3072
    ds_read_b64_tr_b16 v[40:41], v16 offset:4096
    ds_read_b64_tr_b16 v[42:43], v16 offset:5120
    ds_read_b64_tr_b16 v[44:45], v16 offset:6144
    ds_read_b64_tr_b16 v[46:47], v16 offset:7168
    s_waitcnt lgkmcnt(6)
    v_mfma_f32_32x32x16_bf16 v[48:63], a[12:15], v[32:35], v[48:63]
    ds_read_b64_tr_b16 v[32:33], v16 offset:8192
    ds_read_b64_tr_b16 v[34:35], v16 offset:9216
    s_waitcnt lgkmcnt(6)
    v_mfma_f32_32x32x16_bf16 v[48:63], a[16:19], v[36:39], v[48:63]
    ds_read_b64_tr_b16 v[36:37], v16 offset:10240
    ds_read_b64_tr_b16 v[38:39], v16 offset:11264
    s_waitcnt lgkmcnt(6)
    v_mfma_f32_32x32x16_bf16 v[48:63], a[20:23], v[40:43], v[48:63]
    ds_read_b64_tr_b16 v[40:41], v16 offset:12288
    ds_read_b64_tr_b16 v[42:43], v16 offset:13312
    s_waitcnt lgkmcnt(6)
    v_mfma_f32_32x32x16_bf16 v[48:63], a[44:47], v[44:47], v[48:63]
    ds_read_b64_tr_b16 v[44:45], v16 offset:14336
    ds_read_b64_tr_b16 v[46:47], v16 offset:15360
    s_waitcnt lgkmcnt(6)
    v_mfma_f32_32x32x16_bf16 v[48:63], a[48:51], v[32:35], v[48:63]
    ds_read_b64_tr_b16 v[32:33], v16 offset:16384
    ds_read_b64_tr_b16 v[34:35], v16 offset:17408
    s_waitcnt lgkmcnt(6)
    v_mfma_f32_32x32x16_bf16 v[48:63], a[52:55], v[36:39], v[48:63]
    ds_read_b64_tr_b16 v[36:37], v16 offset:18432
    ds_read_b64_tr_b16 v[38:39], v16 offset:19456
    s_waitcnt lgkmcnt(6)
    v_mfma_f32_32x32x16_bf16 v[48:63], a[76:79], v[40:43], v[48:63]
    ds_read_b64_tr_b16 v[40:41], v16 offset:20480
    ds_read_b64_tr_b16 v[42:43], v16 offset:21504
    s_waitcnt lgkmcnt(6)
    v_mfma_f32_32x32x16_bf16 v[48:63], a[80:83], v[44:47], v[48:63]
    ds_read_b64_tr_b16 v[44:45], v16 offset:22528
    ds_read_b64_tr_b16 v[46:47], v16 offset:23552
    s_waitcnt lgkmcnt(6)
    v_mfma_f32_32x32x16_bf16 v[48:63], a[84:87], v[32:35], v[48:63]
    s_waitcnt lgkmcnt(4)
    v_mfma_f32_32x32x16_bf16 v[48:63], a[108:111], v[36:39], v[48:63]
    s_waitcnt lgkmcnt(2)
    v_mfma_f32_32x32x16_bf16 v[48:63], a[112:115], v[40:43], v[48:63]
    s_waitcnt lgkmcnt(0)
    s_mov_b64 exec, 1
    ds_add_u32 v8, v9 offset:92
    s_mov_b64 exec, -1
    v_mfma_f32_32x32x16_bf16 v[48:63], a[116:119], v[44:47], v[48:63]
    s_mov_b32 s44, 524288
sp_41:
    ds_read_b32 v10, v8 offset:92
    s_waitcnt lgkmcnt(0)
    v_readfirstlane_b32 s45, v10
    s_sub_u32 s44, s44, 1
    s_cbranch_scc1 spe_42
    s_cmp_ge_u32 s45, 8
    s_cbranch_scc1 spe_42
    s_sleep 0
    s_branch sp_41
spe_42:
    s_waitcnt vmcnt(2)
    ds_write_b128 v19, v[112:115] offset:0
    ds_write_b128 v19, v[116:119] offset:1024
    s_waitcnt vmcnt(0)
    ds_write_b128 v19, v[120:123] offset:2048
    ds_write_b128 v19, v[124:127] offset:3072
    s_waitcnt lgkmcnt(0)
    s_mov_b64 exec, 1
    ds_add_u32 v8, v9 offset:88
    s_mov_b64 exec, -1
    s_mov_b32 s44, 524288
sp_43:
    ds_read_b32 v10, v8 offset:88
    s_waitcnt lgkmcnt(0)
    v_readfirstlane_b32 s45, v10
    s_sub_u32 s44, s44, 1
    s_cbranch_scc1 spe_44
    s_cmp_ge_u32 s45, 12
    s_cbranch_scc1 spe_44
    s_sleep 0
    s_branch sp_43
spe_44:
    ds_read_b64_tr_b16 v[32:33], v16 offset:0
    ds_read_b64_tr_b16 v[34:35], v16 offset:1024
    ds_read_b64_tr_b16 v[36:37], v16 offset:2048
    ds_read_b64_tr_b16 v[38:39], v16 offset:3072
    ds_read_b64_tr_b16 v[40:41], v16 offset:6144
    ds_read_b64_tr_b16 v[42:43], v16 offset:7168
    ds_read_b64_tr_b16 v[44:45], v16 offset:8192
    ds_read_b64_tr_b16 v[46:47], v16 offset:9216
    s_waitcnt lgkmcnt(6)
    v_mfma_f32_32x32x16_bf16 v[48:63], a[24:27], v[32:35], v[48:63]
    ds_read_b64_tr_b16 v[32:33], v16 offset:12288
    ds_read_b64_tr_b16 v[34:35], v16 offset:13312
    s_waitcnt lgkmcnt(6)
    v_mfma_f32_32x32x16_bf16 v[48:63], a[28:31], v[36:39], v[48:63]
    ds_read_b64_tr_b16 v[36:37], v16 offset:14336
    ds_read_b64_tr_b16 v[38:39], v16 offset:15360
    s_waitcnt lgkmcnt(6)
    v_mfma_f32_32x32x16_bf16 v[48:63], a[56:59], v[40:43], v[48:63]
    ds_read_b64_tr_b16 v[40:41], v16 offset:18432
    ds_read_b64_tr_b16 v[42:43], v16 offset:19456
    s_waitcnt lgkmcnt(6)
    v_mfma_f32_32x32x16_bf16 v[48:63], a[60:63], v[44:47], v[48:63]
    ds_read_b64_tr_b16 v[44:45], v16 offset:20480
    ds_read_b64_tr_b16 v[46:47], v16 offset:21504
    s_waitcnt lgkmcnt(6)
    v_mfma_f32_32x32x16_bf16 v[48:63], a[88:91], v[32:35], v[48:63]
    s_waitcnt lgkmcnt(4)
    v_mfma_f32_32x32x16_bf16 v[48:63], a[92:95], v[36:39], v[48:63]
    s_waitcnt lgkmcnt(2)
    v_mfma_f32_32x32x16_bf16 v[48:63], a[120:123], v[40:43], v[48:63]
    s_waitcnt lgkmcnt(0)
    s_mov_b64 exec, 1
    ds_add_u32 v8, v9 offset:92
    s_mov_b64 exec, -1
    v_mfma_f32_32x32x16_bf16 v[48:63], a[124:127], v[44:47], v[48:63]
    s_mov_b32 s44, 524288
sp_45:
    ds_read_b32 v10, v8 offset:92
    s_waitcnt lgkmcnt(0)
    v_readfirstlane_b32 s45, v10
    s_sub_u32 s44, s44, 1
    s_cbranch_scc1 spe_46
    s_cmp_ge_u32 s45, 12
    s_cbranch_scc1 spe_46
    s_sleep 0
    s_branch sp_45
spe_46:
    s_nop 1
    ds_write_b128 v18, v[48:51] offset:0
    ds_write_b128 v18, v[52:55] offset:1024
    ds_write_b128 v18, v[56:59] offset:2048
    ds_write_b128 v18, v[60:63] offset:3072
    s_waitcnt lgkmcnt(0)
    s_mov_b64 exec, 1
    ds_add_u32 v8, v9 offset:32
    s_mov_b64 exec, -1
    s_endpgm
g_start:
    s_cmp_eq_u32 s3, 3
    s_cbranch_scc1 g_aux
    s_cmp_ge_u32 s3, 1
    s_cbranch_scc1 g_wt
    s_lshl_b32 s25, s22, 8
    s_lshl_b32 s26, s23, 3
    s_add_u32 s25, s25, s26
    v_lshrrev_b32 v3, 4, v2
    v_and_b32 v4, 15, v2
    v_add_u32 v3, s25, v3
    v_lshlrev_b32 v13, 4, v4
    v_lshl_add_u32 v6, v3, 10, v13
    s_waitcnt lgkmcnt(0)
    s_mov_b32 s8, s48
    s_and_b32 s9, s49, 0xffff
    s_mov_b32 s10, 2097152
    s_mov_b32 s11, 0x20000
    s_mov_b32 s16, s64
    s_and_b32 s17, s65, 0xffff
    s_mov_b32 s18, 1024
    s_mov_b32 s19, 0x20000
    s_movk_i32 s26, 0x1000
    buffer_load_dwordx4 v[16:19], v6, s[8:11], 0 offen offset:0
    buffer_load_dwordx4 v[20:23], v6, s[8:11], 0 offen offset:256
    buffer_load_dwordx4 v[24:27], v6, s[8:11], 0 offen offset:512
    buffer_load_dwordx4 v[28:31], v6, s[8:11], 0 offen offset:768
    buffer_load_dwordx4 v[32:35], v6, s[8:11], s26 offen offset:0
    buffer_load_dwordx4 v[36:39], v6, s[8:11], s26 offen offset:256
    buffer_load_dwordx4 v[40:43], v6, s[8:11], s26 offen offset:512
    buffer_load_dwordx4 v[44:47], v6, s[8:11], s26 offen offset:768
    buffer_load_dwordx4 v[48:51], v13, s[16:19], 0 offen offset:0
    buffer_load_dwordx4 v[52:55], v13, s[16:19], 0 offen offset:256
    buffer_load_dwordx4 v[56:59], v13, s[16:19], 0 offen offset:512
    buffer_load_dwordx4 v[60:63], v13, s[16:19], 0 offen offset:768
    s_mov_b32 s12, s70
    s_and_b32 s13, s71, 0xffff
    s_mov_b32 s14, 20971520
    s_mov_b32 s15, 0x20000
    s_barrier
    v_lshrrev_b32 v7, 3, v4
    v_lshlrev_b32 v7, 18, v7
    v_lshl_add_u32 v7, v3, 7, v7
    v_and_b32 v14, 7, v4
    v_lshl_add_u32 v7, v14, 4, v7
    v_lshlrev_b32 v14, 2, v3
    v_cmp_eq_u32 vcc, 0, v4
    s_nop 1
    v_cndmask_b32 v14, v1, v14, vcc
    v_mov_b32 v15, 0x3f803f80
    v_mov_b32 v80, 0
    v_mov_b32 v81, 0
    v_mov_b32 v82, 0
    v_mov_b32 v83, 0
    v_mov_b32 v84, 0
    v_mov_b32 v85, 0
    v_mov_b32 v86, 0
    v_mov_b32 v87, 0
    s_waitcnt vmcnt(4)
    v_dot2_f32_bf16 v80, v16, v15, v80
    v_dot2_f32_bf16 v81, v16, v16, v81
    v_dot2_f32_bf16 v84, v32, v15, v84
    v_dot2_f32_bf16 v85, v32, v32, v85
    v_dot2_f32_bf16 v80, v17, v15, v80
    v_dot2_f32_bf16 v81, v17, v17, v81
    v_dot2_f32_bf16 v84, v33, v15, v84
    v_dot2_f32_bf16 v85, v33, v33, v85
    v_dot2_f32_bf16 v80, v18, v15, v80
    v_dot2_f32_bf16 v81, v18, v18, v81
    v_dot2_f32_bf16 v84, v34, v15, v84
    v_dot2_f32_bf16 v85, v34, v34, v85
    v_dot2_f32_bf16 v80, v19, v15, v80
    v_dot2_f32_bf16 v81, v19, v19, v81
    v_dot2_f32_bf16 v84, v35, v15, v84
    v_dot2_f32_bf16 v85, v35, v35, v85
    v_dot2_f32_bf16 v80, v20, v15, v80
    v_dot2_f32_bf16 v81, v20, v20, v81
    v_dot2_f32_bf16 v84, v36, v15, v84
    v_dot2_f32_bf16 v85, v36, v36, v85
    v_dot2_f32_bf16 v80, v21, v15, v80
    v_dot2_f32_bf16 v81, v21, v21, v81
    v_dot2_f32_bf16 v84, v37, v15, v84
    v_dot2_f32_bf16 v85, v37, v37, v85
    v_dot2_f32_bf16 v80, v22, v15, v80
    v_dot2_f32_bf16 v81, v22, v22, v81
    v_dot2_f32_bf16 v84, v38, v15, v84
    v_dot2_f32_bf16 v85, v38, v38, v85
    v_dot2_f32_bf16 v80, v23, v15, v80
    v_dot2_f32_bf16 v81, v23, v23, v81
    v_dot2_f32_bf16 v84, v39, v15, v84
    v_dot2_f32_bf16 v85, v39, v39, v85
    v_dot2_f32_bf16 v80, v24, v15, v80
    v_dot2_f32_bf16 v81, v24, v24, v81
    v_dot2_f32_bf16 v84, v40, v15, v84
    v_dot2_f32_bf16 v85, v40, v40, v85
    v_dot2_f32_bf16 v80, v25, v15, v80
    v_dot2_f32_bf16 v81, v25, v25, v81
    v_dot2_f32_bf16 v84, v41, v15, v84
    v_dot2_f32_bf16 v85, v41, v41, v85
    v_dot2_f32_bf16 v80, v26, v15, v80
    v_dot2_f32_bf16 v81, v26, v26, v81
    v_dot2_f32_bf16 v84, v42, v15, v84
    v_dot2_f32_bf16 v85, v42, v42, v85
    v_dot2_f32_bf16 v80, v27, v15, v80
    v_dot2_f32_bf16 v81, v27, v27, v81
    v_dot2_f32_bf16 v84, v43, v15, v84
    v_dot2_f32_bf16 v85, v43, v43, v85
    v_dot2_f32_bf16 v80, v28, v15, v80
    v_dot2_f32_bf16 v81, v28, v28, v81
    v_dot2_f32_bf16 v84, v44, v15, v84
    v_dot2_f32_bf16 v85, v44, v44, v85
    v_dot2_f32_bf16 v80, v29, v15, v80
    v_dot2_f32_bf16 v81, v29, v29, v81
    v_dot2_f32_bf16 v84, v45, v15, v84
    v_dot2_f32_bf16 v85, v45, v45, v85
    v_dot2_f32_bf16 v80, v30, v15, v80
    v_dot2_f32_bf16 v81, v30, v30, v81
    v_dot2_f32_bf16 v84, v46, v15, v84
    v_dot2_f32_bf16 v85, v46, v46, v85
    v_dot2_f32_bf16 v80, v31, v15, v80
    v_dot2_f32_bf16 v81, v31, v31, v81
    v_dot2_f32_bf16 v84, v47, v15, v84
    v_dot2_f32_bf16 v85, v47, v47, v85
    s_waitcnt vmcnt(0)
    v_dot2_f32_bf16 v82, v16, v48, v82
    v_dot2_f32_bf16 v86, v32, v48, v86
    v_dot2_f32_bf16 v82, v17, v49, v82
    v_dot2_f32_bf16 v86, v33, v49, v86
    v_dot2_f32_bf16 v82, v18, v50, v82
    v_dot2_f32_bf16 v86, v34, v50, v86
    v_dot2_f32_bf16 v82, v19, v51, v82
    v_dot2_f32_bf16 v86, v35, v51, v86
    v_dot2_f32_bf16 v82, v20, v52, v82
    v_dot2_f32_bf16 v86, v36, v52, v86
    v_dot2_f32_bf16 v82, v21, v53, v82
    v_dot2_f32_bf16 v86, v37, v53, v86
    v_dot2_f32_bf16 v82, v22, v54, v82
    v_dot2_f32_bf16 v86, v38, v54, v86
    v_dot2_f32_bf16 v82, v23, v55, v82
    v_dot2_f32_bf16 v86, v39, v55, v86
    v_dot2_f32_bf16 v82, v24, v56, v82
    v_dot2_f32_bf16 v86, v40, v56, v86
    v_dot2_f32_bf16 v82, v25, v57, v82
    v_dot2_f32_bf16 v86, v41, v57, v86
    v_dot2_f32_bf16 v82, v26, v58, v82
    v_dot2_f32_bf16 v86, v42, v58, v86
    v_dot2_f32_bf16 v82, v27, v59, v82
    v_dot2_f32_bf16 v86, v43, v59, v86
    v_dot2_f32_bf16 v82, v28, v60, v82
    v_dot2_f32_bf16 v86, v44, v60, v86
    v_dot2_f32_bf16 v82, v29, v61, v82
    v_dot2_f32_bf16 v86, v45, v61, v86
    v_dot2_f32_bf16 v82, v30, v62, v82
    v_dot2_f32_bf16 v86, v46, v62, v86
    v_dot2_f32_bf16 v82, v31, v63, v82
    v_dot2_f32_bf16 v86, v47, v63, v86
    s_nop 2
    v_add_f32_dpp v80, v80, v80 row_ror:1 row_mask:0xf bank_mask:0xf
    v_add_f32_dpp v81, v81, v81 row_ror:1 row_mask:0xf bank_mask:0xf
    v_add_f32_dpp v84, v84, v84 row_ror:1 row_mask:0xf bank_mask:0xf
    v_add_f32_dpp v85, v85, v85 row_ror:1 row_mask:0xf bank_mask:0xf
    v_add_f32_dpp v82, v82, v82 row_ror:1 row_mask:0xf bank_mask:0xf
    v_add_f32_dpp v86, v86, v86 row_ror:1 row_mask:0xf bank_mask:0xf
    v_add_f32_dpp v80, v80, v80 row_ror:2 row_mask:0xf bank_mask:0xf
    v_add_f32_dpp v81, v81, v81 row_ror:2 row_mask:0xf bank_mask:0xf
    v_add_f32_dpp v84, v84, v84 row_ror:2 row_mask:0xf bank_mask:0xf
    v_add_f32_dpp v85, v85, v85 row_ror:2 row_mask:0xf bank_mask:0xf
    v_add_f32_dpp v82, v82, v82 row_ror:2 row_mask:0xf bank_mask:0xf
    v_add_f32_dpp v86, v86, v86 row_ror:2 row_mask:0xf bank_mask:0xf
    v_add_f32_dpp v80, v80, v80 row_ror:4 row_mask:0xf bank_mask:0xf
    v_add_f32_dpp v81, v81, v81 row_ror:4 row_mask:0xf bank_mask:0xf
    v_add_f32_dpp v84, v84, v84 row_ror:4 row_mask:0xf bank_mask:0xf
    v_add_f32_dpp v85, v85, v85 row_ror:4 row_mask:0xf bank_mask:0xf
    v_add_f32_dpp v82, v82, v82 row_ror:4 row_mask:0xf bank_mask:0xf
    v_add_f32_dpp v86, v86, v86 row_ror:4 row_mask:0xf bank_mask:0xf
    v_add_f32_dpp v80, v80, v80 row_ror:8 row_mask:0xf bank_mask:0xf
    v_add_f32_dpp v81, v81, v81 row_ror:8 row_mask:0xf bank_mask:0xf
    v_add_f32_dpp v84, v84, v84 row_ror:8 row_mask:0xf bank_mask:0xf
    v_add_f32_dpp v85, v85, v85 row_ror:8 row_mask:0xf bank_mask:0xf
    v_add_f32_dpp v82, v82, v82 row_ror:8 row_mask:0xf bank_mask:0xf
    v_add_f32_dpp v86, v86, v86 row_ror:8 row_mask:0xf bank_mask:0xf
    v_mul_f32 v80, 0x3b000000, v80
    v_mul_f32 v84, 0x3b000000, v84
    v_mul_f32 v81, 0x3b000000, v81
    v_mul_f32 v85, 0x3b000000, v85
    v_fma_f32 v81, -v80, v80, v81
    v_fma_f32 v85, -v84, v84, v85
    v_max_f32 v81, 0, v81
    v_max_f32 v85, 0, v85
    v_add_f32 v81, 0x3727c5ac, v81
    v_add_f32 v85, 0x3727c5ac, v85
    v_rsq_f32 v81, v81
    v_rsq_f32 v85, v85
    v_mul_f32 v82, 0xbfb8aa3b, v82
    v_mul_f32 v86, 0xbfb8aa3b, v86
    v_exp_f32 v82, v82
    v_exp_f32 v86, v86
    v_mul_f32 v80, v80, v81
    v_mul_f32 v84, v84, v85
    v_sub_f32 v80, 0, v80
    v_sub_f32 v84, 0, v84
    v_add_f32 v82, 1.0, v82
    v_add_f32 v86, 1.0, v86
    v_rcp_f32 v82, v82
    v_rcp_f32 v86, v86
    v_lshlrev_b32 v64, 16, v16
    v_and_b32 v16, 0xffff0000, v16
    v_fma_f32 v64, v64, v81, v80
    v_fma_f32 v16, v16, v81, v80
    v_cvt_pk_bf16_f32 v16, v64, v16
    v_lshlrev_b32 v65, 16, v17
    v_and_b32 v17, 0xffff0000, v17
    v_fma_f32 v65, v65, v81, v80
    v_fma_f32 v17, v17, v81, v80
    v_cvt_pk_bf16_f32 v17, v65, v17
    v_lshlrev_b32 v66, 16, v18
    v_and_b32 v18, 0xffff0000, v18
    v_fma_f32 v66, v66, v81, v80
    v_fma_f32 v18, v18, v81, v80
    v_cvt_pk_bf16_f32 v18, v66, v18
    v_lshlrev_b32 v67, 16, v19
    v_and_b32 v19, 0xffff0000, v19
    v_fma_f32 v67, v67, v81, v80
    v_fma_f32 v19, v19, v81, v80
    v_cvt_pk_bf16_f32 v19, v67, v19
    s_mov_b32 s36, 1048576
    buffer_store_dwordx4 v[16:19], v7, s[12:15], s36 offen offset:0 sc1
    v_lshlrev_b32 v68, 16, v20
    v_and_b32 v20, 0xffff0000, v20
    v_fma_f32 v68, v68, v81, v80
    v_fma_f32 v20, v20, v81, v80
    v_cvt_pk_bf16_f32 v20, v68, v20
    v_lshlrev_b32 v69, 16, v21
    v_and_b32 v21, 0xffff0000, v21
    v_fma_f32 v69, v69, v81, v80
    v_fma_f32 v21, v21, v81, v80
    v_cvt_pk_bf16_f32 v21, v69, v21
    v_lshlrev_b32 v70, 16, v22
    v_and_b32 v22, 0xffff0000, v22
    v_fma_f32 v70, v70, v81, v80
    v_fma_f32 v22, v22, v81, v80
    v_cvt_pk_bf16_f32 v22, v70, v22
    v_lshlrev_b32 v71, 16, v23
    v_and_b32 v23, 0xffff0000, v23
    v_fma_f32 v71, v71, v81, v80
    v_fma_f32 v23, v23, v81, v80
    v_cvt_pk_bf16_f32 v23, v71, v23
    s_mov_b32 s36, 1572864
    buffer_store_dwordx4 v[20:23], v7, s[12:15], s36 offen offset:0 sc1
    v_lshlrev_b32 v72, 16, v24
    v_and_b32 v24, 0xffff0000, v24
    v_fma_f32 v72, v72, v81, v80
    v_fma_f32 v24, v24, v81, v80
    v_cvt_pk_bf16_f32 v24, v72, v24
    v_lshlrev_b32 v73, 16, v25
    v_and_b32 v25, 0xffff0000, v25
    v_fma_f32 v73, v73, v81, v80
    v_fma_f32 v25, v25, v81, v80
    v_cvt_pk_bf16_f32 v25, v73, v25
    v_lshlrev_b32 v74, 16, v26
    v_and_b32 v26, 0xffff0000, v26
    v_fma_f32 v74, v74, v81, v80
    v_fma_f32 v26, v26, v81, v80
    v_cvt_pk_bf16_f32 v26, v74, v26
    v_lshlrev_b32 v75, 16, v27
    v_and_b32 v27, 0xffff0000, v27
    v_fma_f32 v75, v75, v81, v80
    v_fma_f32 v27, v27, v81, v80
    v_cvt_pk_bf16_f32 v27, v75, v27
    s_mov_b32 s36, 2097152
    buffer_store_dwordx4 v[24:27], v7, s[12:15], s36 offen offset:0 sc1
    v_lshlrev_b32 v76, 16, v28
    v_and_b32 v28, 0xffff0000, v28
    v_fma_f32 v76, v76, v81, v80
    v_fma_f32 v28, v28, v81, v80
    v_cvt_pk_bf16_f32 v28, v76, v28
    v_lshlrev_b32 v77, 16, v29
    v_and_b32 v29, 0xffff0000, v29
    v_fma_f32 v77, v77, v81, v80
    v_fma_f32 v29, v29, v81, v80
    v_cvt_pk_bf16_f32 v29, v77, v29
    v_lshlrev_b32 v78, 16, v30
    v_and_b32 v30, 0xffff0000, v30
    v_fma_f32 v78, v78, v81, v80
    v_fma_f32 v30, v30, v81, v80
    v_cvt_pk_bf16_f32 v30, v78, v30
    v_lshlrev_b32 v79, 16, v31
    v_and_b32 v31, 0xffff0000, v31
    v_fma_f32 v79, v79, v81, v80
    v_fma_f32 v31, v31, v81, v80
    v_cvt_pk_bf16_f32 v31, v79, v31
    s_mov_b32 s36, 2621440
    buffer_store_dwordx4 v[28:31], v7, s[12:15], s36 offen offset:0 sc1
    v_sub_f32 v83, 1.0, v82
    v_mul_f32 v82, 0x36000000, v82
    s_mov_b32 s36, 10485760
    s_mov_b32 s37, 10502144
    buffer_store_dword v82, v14, s[12:15], s36 offen offset:0 sc1
    buffer_store_dword v83, v14, s[12:15], s37 offen offset:0 sc1
    v_lshlrev_b32 v64, 16, v32
    v_and_b32 v32, 0xffff0000, v32
    v_fma_f32 v64, v64, v85, v84
    v_fma_f32 v32, v32, v85, v84
    v_cvt_pk_bf16_f32 v32, v64, v32
    v_lshlrev_b32 v65, 16, v33
    v_and_b32 v33, 0xffff0000, v33
    v_fma_f32 v65, v65, v85, v84
    v_fma_f32 v33, v33, v85, v84
    v_cvt_pk_bf16_f32 v33, v65, v33
    v_lshlrev_b32 v66, 16, v34
    v_and_b32 v34, 0xffff0000, v34
    v_fma_f32 v66, v66, v85, v84
    v_fma_f32 v34, v34, v85, v84
    v_cvt_pk_bf16_f32 v34, v66, v34
    v_lshlrev_b32 v67, 16, v35
    v_and_b32 v35, 0xffff0000, v35
    v_fma_f32 v67, v67, v85, v84
    v_fma_f32 v35, v35, v85, v84
    v_cvt_pk_bf16_f32 v35, v67, v35
    s_mov_b32 s36, 1048576
    buffer_store_dwordx4 v[32:35], v7, s[12:15], s36 offen offset:512 sc1
    v_lshlrev_b32 v68, 16, v36
    v_and_b32 v36, 0xffff0000, v36
    v_fma_f32 v68, v68, v85, v84
    v_fma_f32 v36, v36, v85, v84
    v_cvt_pk_bf16_f32 v36, v68, v36
    v_lshlrev_b32 v69, 16, v37
    v_and_b32 v37, 0xffff0000, v37
    v_fma_f32 v69, v69, v85, v84
    v_fma_f32 v37, v37, v85, v84
    v_cvt_pk_bf16_f32 v37, v69, v37
    v_lshlrev_b32 v70, 16, v38
    v_and_b32 v38, 0xffff0000, v38
    v_fma_f32 v70, v70, v85, v84
    v_fma_f32 v38, v38, v85, v84
    v_cvt_pk_bf16_f32 v38, v70, v38
    v_lshlrev_b32 v71, 16, v39
    v_and_b32 v39, 0xffff0000, v39
    v_fma_f32 v71, v71, v85, v84
    v_fma_f32 v39, v39, v85, v84
    v_cvt_pk_bf16_f32 v39, v71, v39
    s_mov_b32 s36, 1572864
    buffer_store_dwordx4 v[36:39], v7, s[12:15], s36 offen offset:512 sc1
    v_lshlrev_b32 v72, 16, v40
    v_and_b32 v40, 0xffff0000, v40
    v_fma_f32 v72, v72, v85, v84
    v_fma_f32 v40, v40, v85, v84
    v_cvt_pk_bf16_f32 v40, v72, v40
    v_lshlrev_b32 v73, 16, v41
    v_and_b32 v41, 0xffff0000, v41
    v_fma_f32 v73, v73, v85, v84
    v_fma_f32 v41, v41, v85, v84
    v_cvt_pk_bf16_f32 v41, v73, v41
    v_lshlrev_b32 v74, 16, v42
    v_and_b32 v42, 0xffff0000, v42
    v_fma_f32 v74, v74, v85, v84
    v_fma_f32 v42, v42, v85, v84
    v_cvt_pk_bf16_f32 v42, v74, v42
    v_lshlrev_b32 v75, 16, v43
    v_and_b32 v43, 0xffff0000, v43
    v_fma_f32 v75, v75, v85, v84
    v_fma_f32 v43, v43, v85, v84
    v_cvt_pk_bf16_f32 v43, v75, v43
    s_mov_b32 s36, 2097152
    buffer_store_dwordx4 v[40:43], v7, s[12:15], s36 offen offset:512 sc1
    v_lshlrev_b32 v76, 16, v44
    v_and_b32 v44, 0xffff0000, v44
    v_fma_f32 v76, v76, v85, v84
    v_fma_f32 v44, v44, v85, v84
    v_cvt_pk_bf16_f32 v44, v76, v44
    v_lshlrev_b32 v77, 16, v45
    v_and_b32 v45, 0xffff0000, v45
    v_fma_f32 v77, v77, v85, v84
    v_fma_f32 v45, v45, v85, v84
    v_cvt_pk_bf16_f32 v45, v77, v45
    v_lshlrev_b32 v78, 16, v46
    v_and_b32 v46, 0xffff0000, v46
    v_fma_f32 v78, v78, v85, v84
    v_fma_f32 v46, v46, v85, v84
    v_cvt_pk_bf16_f32 v46, v78, v46
    v_lshlrev_b32 v79, 16, v47
    v_and_b32 v47, 0xffff0000, v47
    v_fma_f32 v79, v79, v85, v84
    v_fma_f32 v47, v47, v85, v84
    v_cvt_pk_bf16_f32 v47, v79, v47
    s_mov_b32 s36, 2621440
    buffer_store_dwordx4 v[44:47], v7, s[12:15], s36 offen offset:512 sc1
    v_sub_f32 v87, 1.0, v86
    v_mul_f32 v86, 0x36000000, v86
    s_mov_b32 s36, 10485760
    s_mov_b32 s37, 10502144
    buffer_store_dword v86, v14, s[12:15], s36 offen offset:16 sc1
    buffer_store_dword v87, v14, s[12:15], s37 offen offset:16 sc1
    s_branch g_p1done
g_aux:
    v_lshrrev_b32 v126, 2, v2
    v_and_b32 v127, 3, v2
    v_lshlrev_b32 v127, 7, v127
    s_cmp_ge_u32 s23, 28
    s_cbranch_scc1 g_aux2
    v_mul_u32_u24 v124, 3584, v126
    v_add_u32 v124, v124, v127
    s_mul_i32 s36, s22, 28
    s_lshr_b32 s36, s36, 3
    s_lshl_b32 s36, s36, 7
    s_waitcnt lgkmcnt(0)
    s_mov_b32 s92, s56
    s_and_b32 s93, s57, 0xffff
    s_mov_b32 s94, 7340032
    s_mov_b32 s95, 0x20000
    s_mov_b32 s12, s70
    s_and_b32 s13, s71, 0xffff
    s_mov_b32 s14, 20971520
    s_mov_b32 s15, 0x20000
    s_barrier
    s_mov_b64 exec, 1
    ds_add_rtn_u32 v10, v8, v9 offset:4
    s_mov_b64 exec, -1
    s_waitcnt lgkmcnt(0)
    v_readfirstlane_b32 s45, v10
    s_nop 1
    s_cmp_lg_u32 s45, 7
    s_cbranch_scc1 pube_47
    s_setprio 3
    s_mov_b32 s44, 524288
sp_48:
    ds_read_b32 v10, v8 offset:40
    s_waitcnt lgkmcnt(0)
    v_readfirstlane_b32 s45, v10
    s_sub_u32 s44, s44, 1
    s_cbranch_scc1 spe_49
    s_cmp_ge_u32 s45, 1
    s_cbranch_scc1 spe_49
    s_sleep 1
    s_branch sp_48
spe_49:
    v_mov_b32 v10, s45
    s_mov_b32 s44, 10551296
    s_mov_b64 exec, 255
    buffer_store_dword v10, v11, s[12:15], s44 offen sc1
    s_mov_b64 exec, 1
    ds_write_b32 v8, v9 offset:52
    s_mov_b64 exec, -1
    s_setprio 0
pube_47:
    s_add_u32 s5, s23, 0
    s_and_b32 s6, s5, 3
    s_mul_i32 s6, s6, 32
    s_lshr_b32 s5, s5, 2
    s_add_u32 s6, s6, s5
    s_mul_i32 s6, s6, 57344
    s_add_u32 s6, s6, s36
    s_waitcnt vmcnt(1)
    buffer_load_dword v96, v124, s[92:95], s6 offen
    s_add_u32 s5, s23, 28
    s_and_b32 s6, s5, 3
    s_mul_i32 s6, s6, 32
    s_lshr_b32 s5, s5, 2
    s_add_u32 s6, s6, s5
    s_mul_i32 s6, s6, 57344
    s_add_u32 s6, s6, s36
    s_waitcnt vmcnt(1)
    buffer_load_dword v97, v124, s[92:95], s6 offen
    s_add_u32 s5, s23, 56
    s_and_b32 s6, s5, 3
    s_mul_i32 s6, s6, 32
    s_lshr_b32 s5, s5, 2
    s_add_u32 s6, s6, s5
    s_mul_i32 s6, s6, 57344
    s_add_u32 s6, s6, s36
    s_waitcnt vmcnt(1)
    buffer_load_dword v98, v124, s[92:95], s6 offen
    s_add_u32 s5, s23, 84
    s_and_b32 s6, s5, 3
    s_mul_i32 s6, s6, 32
    s_lshr_b32 s5, s5, 2
    s_add_u32 s6, s6, s5
    s_mul_i32 s6, s6, 57344
    s_add_u32 s6, s6, s36
    s_waitcnt vmcnt(1)
    buffer_load_dword v99, v124, s[92:95], s6 offen
    s_add_u32 s5, s23, 112
    s_and_b32 s6, s5, 3
    s_mul_i32 s6, s6, 32
    s_lshr_b32 s5, s5, 2
    s_add_u32 s6, s6, s5
    s_mul_i32 s6, s6, 57344
    s_add_u32 s6, s6, s36
    s_cmp_lt_u32 s5, 32
    s_cselect_b32 s6, s6, 0x40000000
    s_waitcnt vmcnt(1)
    buffer_load_dword v100, v124, s[92:95], s6 offen
    s_branch g_p1pub
g_aux2:
    v_lshl_add_u32 v124, v126, 12, v127
    s_sub_u32 s36, s23, 28
    s_mul_i32 s36, s36, 1835008
    s_lshl_b32 s37, s22, 9
    s_add_u32 s36, s36, s37
    s_waitcnt lgkmcnt(0)
    s_mov_b32 s92, s60
    s_and_b32 s93, s61, 0xffff
    s_mov_b32 s94, 7340032
    s_mov_b32 s95, 0x20000
    s_mov_b32 s12, s70
    s_and_b32 s13, s71, 0xffff
    s_mov_b32 s14, 20971520
    s_mov_b32 s15, 0x20000
    s_barrier
    s_mov_b64 exec, 1
    ds_add_rtn_u32 v10, v8, v9 offset:4
    s_mov_b64 exec, -1
    s_waitcnt lgkmcnt(0)
    v_readfirstlane_b32 s45, v10
    s_nop 1
    s_cmp_lg_u32 s45, 7
    s_cbranch_scc1 pube_50
    s_setprio 3
    s_mov_b32 s44, 524288
sp_51:
    ds_read_b32 v10, v8 offset:40
    s_waitcnt lgkmcnt(0)
    v_readfirstlane_b32 s45, v10
    s_sub_u32 s44, s44, 1
    s_cbranch_scc1 spe_52
    s_cmp_ge_u32 s45, 1
    s_cbranch_scc1 spe_52
    s_sleep 1
    s_branch sp_51
spe_52:
    v_mov_b32 v10, s45
    s_mov_b32 s44, 10551296
    s_mov_b64 exec, 255
    buffer_store_dword v10, v11, s[12:15], s44 offen sc1
    s_mov_b64 exec, 1
    ds_write_b32 v8, v9 offset:52
    s_mov_b64 exec, -1
    s_setprio 0
pube_50:
    s_branch g_p1pub
g_wt:
    s_lshl_b32 s32, s22, 3
    s_lshr_b32 s33, s23, 2
    s_add_u32 s32, s32, s33
    s_and_b32 s33, s32, 1
    s_lshr_b32 s32, s32, 1
    s_and_b32 s34, s32, 7
    s_lshr_b32 s35, s32, 3
    s_lshl_b32 s36, s35, 4
    s_lshl_b32 s37, s33, 3
    s_add_u32 s36, s36, s37
    s_lshl_b32 s37, s34, 8
    s_add_u32 s36, s36, s37
    s_mul_i32 s36, s36, 514
    s_and_b32 s24, s23, 3
    s_lshl_b32 s24, s24, 1
    s_add_u32 s24, s24, s3
    s_sub_u32 s24, s24, 1
    s_lshl_b32 s25, s24, 6
    s_add_u32 s40, s36, s25
    s_add_u32 s41, s40, 32896
    s_add_u32 s42, s40, 65792
    s_add_u32 s43, s40, 98688
    s_lshl_b32 s26, s35, 11
    s_lshl_b32 s27, s34, 8
    s_add_u32 s26, s26, s27
    s_lshl_b32 s27, s33, 7
    s_add_u32 s26, s26, s27
    s_add_u32 s26, s26, 7340032
    s_lshl_b32 s27, s24, 18
    s_add_u32 s27, s27, s26
    v_and_b32 v3, 7, v2
    v_lshrrev_b32 v4, 3, v2
    v_mul_u32_u24 v6, 514, v3
    v_lshl_add_u32 v6, v4, 2, v6
    v_lshlrev_b32 v7, 14, v4
    v_lshl_add_u32 v7, v3, 4, v7
    v_add_u32 v13, 8192, v7
    s_waitcnt lgkmcnt(0)
    s_mov_b32 s92, s68
    s_and_b32 s93, s69, 0xffff
    s_mov_b32 s94, 256
    s_mov_b32 s95, 0x20000
    v_mov_b32 v50, 0
    buffer_load_dword v51, v50, s[92:95], 0 offen sc1
    s_mov_b32 s16, s50
    s_and_b32 s17, s51, 0xffff
    s_mov_b32 s18, 1052672
    s_mov_b32 s19, 0x20000
    s_mov_b32 s28, s52
    s_and_b32 s29, s53, 0xffff
    s_mov_b32 s30, 1052672
    s_mov_b32 s31, 0x20000
    buffer_load_dword v16, v6, s[16:19], s40 offen offset:0
    buffer_load_dword v24, v6, s[28:31], s40 offen offset:0
    buffer_load_dword v17, v6, s[16:19], s41 offen offset:0
    buffer_load_dword v25, v6, s[28:31], s41 offen offset:0
    buffer_load_dword v18, v6, s[16:19], s42 offen offset:0
    buffer_load_dword v26, v6, s[28:31], s42 offen offset:0
    buffer_load_dword v19, v6, s[16:19], s43 offen offset:0
    buffer_load_dword v27, v6, s[28:31], s43 offen offset:0
    buffer_load_dword v20, v6, s[16:19], s40 offen offset:32
    buffer_load_dword v28, v6, s[28:31], s40 offen offset:32
    buffer_load_dword v21, v6, s[16:19], s41 offen offset:32
    buffer_load_dword v29, v6, s[28:31], s41 offen offset:32
    buffer_load_dword v22, v6, s[16:19], s42 offen offset:32
    buffer_load_dword v30, v6, s[28:31], s42 offen offset:32
    buffer_load_dword v23, v6, s[16:19], s43 offen offset:32
    buffer_load_dword v31, v6, s[28:31], s43 offen offset:32
    v_lshrrev_b32 v14, 2, v2
    v_and_b32 v15, 3, v2
    v_lshl_add_u32 v14, v15, 6, v14
    v_mul_u32_u24 v14, 514, v14
    v_add_u32 v14, 512, v14
    v_lshlrev_b32 v15, 2, v2
    v_add_u32 v15, 2097152, v15
    v_cmp_lt_u32 vcc, 31, v2
    s_cmp_eq_u32 s24, 0
    s_nop 0
    s_cselect_b64 s[38:39], vcc, -1
    v_cndmask_b32 v14, v14, v1, s[38:39]
    v_cndmask_b32 v15, v15, v1, s[38:39]
    buffer_load_ushort v48, v14, s[16:19], s36 offen
    buffer_load_ushort v49, v14, s[28:31], s36 offen
    s_mov_b32 s12, s70
    s_and_b32 s13, s71, 0xffff
    s_mov_b32 s14, 20971520
    s_mov_b32 s15, 0x20000
    s_barrier
    s_cmp_lg_u32 s2, 0
    s_cbranch_scc1 g_nocreate
    s_cmp_lg_u32 s3, 1
    s_cbranch_scc1 g_nocreate
    s_waitcnt vmcnt(18)
    v_readfirstlane_b32 s45, v51
    s_nop 1
    s_cmp_lg_u32 s45, 0
    s_cbranch_scc1 g_nocreate
    s_memrealtime s[38:39]
    s_waitcnt lgkmcnt(0)
    s_mul_i32 s39, s39, 0x9e3779b1
    s_xor_b32 s38, s38, s39
    s_or_b32 s38, s38, 1
    v_mov_b32 v52, s38
    s_mov_b64 exec, 1
    buffer_store_dword v52, v50, s[92:95], 0 offen sc1
    s_mov_b64 exec, -1
g_nocreate:
    s_mov_b32 s38, 0x05040100
    s_mov_b32 s39, 0x07060302
    s_waitcnt vmcnt(10)
    v_perm_b32 v32, v24, v16, s38
    v_perm_b32 v33, v25, v17, s38
    v_perm_b32 v34, v26, v18, s38
    v_perm_b32 v35, v27, v19, s38
    v_perm_b32 v36, v24, v16, s39
    v_perm_b32 v37, v25, v17, s39
    v_perm_b32 v38, v26, v18, s39
    v_perm_b32 v39, v27, v19, s39
    s_add_u32 s25, s27, 0
    buffer_store_dwordx4 v[32:35], v7, s[12:15], s25 offen sc1
    buffer_store_dwordx4 v[36:39], v13, s[12:15], s25 offen sc1
    s_waitcnt vmcnt(4)
    v_perm_b32 v40, v28, v20, s38
    v_perm_b32 v41, v29, v21, s38
    v_perm_b32 v42, v30, v22, s38
    v_perm_b32 v43, v31, v23, s38
    v_perm_b32 v44, v28, v20, s39
    v_perm_b32 v45, v29, v21, s39
    v_perm_b32 v46, v30, v22, s39
    v_perm_b32 v47, v31, v23, s39
    s_add_u32 s25, s27, 131072
    buffer_store_dwordx4 v[40:43], v7, s[12:15], s25 offen sc1
    buffer_store_dwordx4 v[44:47], v13, s[12:15], s25 offen sc1
    s_waitcnt vmcnt(4)
    v_lshl_or_b32 v48, v49, 16, v48
    buffer_store_dword v48, v15, s[12:15], s26 offen sc1
    s_cmp_lg_u32 s3, 1
    s_cbranch_scc1 g_p1done
    s_mov_b32 s44, 65536
g_npoll:
    v_readfirstlane_b32 s45, v51
    s_sub_u32 s44, s44, 1
    s_cbranch_scc1 g_ngot
    s_cmp_lg_u32 s45, 0
    s_cbranch_scc1 g_ngot
    buffer_load_dword v51, v50, s[92:95], 0 offen sc1
    s_waitcnt vmcnt(0)
    s_branch g_npoll
g_ngot:
    v_or_b32 v51, 1, v51
    s_mov_b64 exec, 1
    ds_write_b32 v8, v51 offset:40
    s_mov_b64 exec, -1
g_p1done:
    s_waitcnt vmcnt(0)
    s_mov_b64 exec, 1
    ds_add_rtn_u32 v10, v8, v9 offset:4
    s_mov_b64 exec, -1
    s_waitcnt lgkmcnt(0)
    v_readfirstlane_b32 s45, v10
    s_nop 1
    s_cmp_lg_u32 s45, 7
    s_cbranch_scc1 pube_53
    s_setprio 3
    s_mov_b32 s44, 524288
sp_54:
    ds_read_b32 v10, v8 offset:40
    s_waitcnt lgkmcnt(0)
    v_readfirstlane_b32 s45, v10
    s_sub_u32 s44, s44, 1
    s_cbranch_scc1 spe_55
    s_cmp_ge_u32 s45, 1
    s_cbranch_scc1 spe_55
    s_sleep 1
    s_branch sp_54
spe_55:
    v_mov_b32 v10, s45
    s_mov_b32 s44, 10551296
    s_mov_b64 exec, 255
    buffer_store_dword v10, v11, s[12:15], s44 offen sc1
    s_mov_b64 exec, 1
    ds_write_b32 v8, v9 offset:52
    s_mov_b64 exec, -1
    s_setprio 0
pube_53:
g_p1pub:
    s_mul_i32 s25, s22, 28
    s_add_u32 s25, s25, s23
    s_and_b32 s24, s25, 7
    s_lshr_b32 s25, s25, 3
    v_lshrrev_b32 v3, 3, v2
    v_bfe_u32 v4, v2, 4, 1
    v_lshlrev_b32 v4, 2, v4
    v_xor_b32 v4, v4, v2
    v_and_b32 v4, 7, v4
    v_lshlrev_b32 v4, 4, v4
    v_mul_u32_u24 v13, 3584, v3
    s_lshl_b32 s38, s25, 7
    v_add3_u32 v13, v13, v4, s38
    v_add_u32 v14, 27648, v13
    v_lshl_add_u32 v15, v3, 7, v4
    s_lshl_b32 s41, s24, 18
    s_add_u32 s41, s41, 1048576
    s_lshl_b32 s26, s3, 16
    s_add_u32 s41, s41, s26
    s_mul_i32 s40, s3, 1835008
    s_lshl_b32 s42, s3, 15
    s_lshr_b32 s34, s3, 1
    s_and_b32 s35, s3, 1
    v_bfe_u32 v21, v2, 2, 2
    v_lshrrev_b32 v22, 5, v2
    v_lshl_add_u32 v20, v22, 2, v21
    v_lshlrev_b32 v20, 7, v20
    v_lshrrev_b32 v21, 1, v21
    v_lshl_add_u32 v20, v21, 6, v20
    v_bfe_u32 v21, v2, 4, 1
    v_lshl_add_u32 v20, v21, 5, v20
    v_and_b32 v21, 3, v2
    v_lshl_add_u32 v20, v21, 3, v20
    v_add_u32 v20, s42, v20
    s_lshl_b32 s26, s34, 6
    v_xor_b32 v16, s26, v20
    v_xor_b32 v17, 64, v16
    s_lshl_b32 s26, s35, 6
    v_xor_b32 v18, s26, v20
    v_xor_b32 v19, 64, v18
    s_mov_b32 s8, s56
    s_and_b32 s9, s57, 0xffff
    s_mov_b32 s10, 7340032
    s_mov_b32 s11, 0x20000
    s_mov_b32 s44, 524288
sp_56:
    ds_read_b32 v10, v8 offset:52
    s_waitcnt lgkmcnt(0)
    v_readfirstlane_b32 s45, v10
    s_sub_u32 s44, s44, 1
    s_cbranch_scc1 spe_57
    s_cmp_ge_u32 s45, 1
    s_cbranch_scc1 spe_57
    s_sleep 1
    s_branch sp_56
spe_57:
    s_cmp_ge_u32 s23, 28
    s_cbranch_scc1 g_spare
    s_setprio 2
    s_add_u32 m0, s42, 0
    s_add_u32 s43, s40, 0
    buffer_load_dwordx4 v13, s[8:11], s43 offen lds
    buffer_load_dwordx4 v14, s[8:11], s43 offen offset:1024 lds
    s_add_u32 m0, s42, 2048
    s_add_u32 s43, s40, 57344
    buffer_load_dwordx4 v13, s[8:11], s43 offen lds
    buffer_load_dwordx4 v14, s[8:11], s43 offen offset:1024 lds
    s_add_u32 m0, s42, 4096
    s_add_u32 s43, s40, 114688
    buffer_load_dwordx4 v13, s[8:11], s43 offen lds
    buffer_load_dwordx4 v14, s[8:11], s43 offen offset:1024 lds
    s_add_u32 m0, s42, 6144
    s_add_u32 s43, s40, 172032
    buffer_load_dwordx4 v13, s[8:11], s43 offen lds
    buffer_load_dwordx4 v14, s[8:11], s43 offen offset:1024 lds
    s_add_u32 m0, s42, 8192
    s_add_u32 s43, s40, 229376
    buffer_load_dwordx4 v13, s[8:11], s43 offen lds
    buffer_load_dwordx4 v14, s[8:11], s43 offen offset:1024 lds
    s_add_u32 m0, s42, 10240
    s_add_u32 s43, s40, 286720
    buffer_load_dwordx4 v13, s[8:11], s43 offen lds
    buffer_load_dwordx4 v14, s[8:11], s43 offen offset:1024 lds
    s_add_u32 m0, s42, 12288
    s_add_u32 s43, s40, 344064
    buffer_load_dwordx4 v13, s[8:11], s43 offen lds
    buffer_load_dwordx4 v14, s[8:11], s43 offen offset:1024 lds
    s_add_u32 m0, s42, 14336
    s_add_u32 s43, s40, 401408
    buffer_load_dwordx4 v13, s[8:11], s43 offen lds
    buffer_load_dwordx4 v14, s[8:11], s43 offen offset:1024 lds
    s_waitcnt vmcnt(14)
    ds_read_b64_tr_b16 a[0:1], v16 offset:0
    ds_read_b64_tr_b16 a[2:3], v16 offset:1024
    ds_read_b64_tr_b16 a[4:5], v17 offset:0
    ds_read_b64_tr_b16 a[6:7], v17 offset:1024
    s_waitcnt lgkmcnt(0)
    s_add_u32 m0, s42, 0
    s_add_u32 s43, s40, 458752
    buffer_load_dwordx4 v13, s[8:11], s43 offen lds
    buffer_load_dwordx4 v14, s[8:11], s43 offen offset:1024 lds
    s_waitcnt vmcnt(14)
    ds_read_b64_tr_b16 a[8:9], v16 offset:2048
    ds_read_b64_tr_b16 a[10:11], v16 offset:3072
    ds_read_b64_tr_b16 a[12:13], v17 offset:2048
    ds_read_b64_tr_b16 a[14:15], v17 offset:3072
    s_waitcnt lgkmcnt(0)
    s_add_u32 m0, s42, 2048
    s_add_u32 s43, s40, 516096
    buffer_load_dwordx4 v13, s[8:11], s43 offen lds
    buffer_load_dwordx4 v14, s[8:11], s43 offen offset:1024 lds
    s_waitcnt vmcnt(14)
    ds_read_b64_tr_b16 a[16:17], v16 offset:4096
    ds_read_b64_tr_b16 a[18:19], v16 offset:5120
    ds_read_b64_tr_b16 a[20:21], v17 offset:4096
    ds_read_b64_tr_b16 a[22:23], v17 offset:5120
    s_waitcnt lgkmcnt(0)
    s_add_u32 m0, s42, 4096
    s_add_u32 s43, s40, 573440
    buffer_load_dwordx4 v13, s[8:11], s43 offen lds
    buffer_load_dwordx4 v14, s[8:11], s43 offen offset:1024 lds
    s_waitcnt vmcnt(14)
    ds_read_b64_tr_b16 a[24:25], v16 offset:6144
    ds_read_b64_tr_b16 a[26:27], v16 offset:7168
    ds_read_b64_tr_b16 a[28:29], v17 offset:6144
    ds_read_b64_tr_b16 a[30:31], v17 offset:7168
    s_waitcnt lgkmcnt(0)
    s_add_u32 m0, s42, 6144
    s_add_u32 s43, s40, 630784
    buffer_load_dwordx4 v13, s[8:11], s43 offen lds
    buffer_load_dwordx4 v14, s[8:11], s43 offen offset:1024 lds
    s_waitcnt vmcnt(14)
    ds_read_b64_tr_b16 a[32:33], v16 offset:8192
    ds_read_b64_tr_b16 a[34:35], v16 offset:9216
    ds_read_b64_tr_b16 a[36:37], v17 offset:8192
    ds_read_b64_tr_b16 a[38:39], v17 offset:9216
    s_waitcnt lgkmcnt(0)
    s_add_u32 m0, s42, 8192
    s_add_u32 s43, s40, 688128
    buffer_load_dwordx4 v13, s[8:11], s43 offen lds
    buffer_load_dwordx4 v14, s[8:11], s43 offen offset:1024 lds
    s_waitcnt vmcnt(14)
    ds_read_b64_tr_b16 a[40:41], v16 offset:10240
    ds_read_b64_tr_b16 a[42:43], v16 offset:11264
    ds_read_b64_tr_b16 a[44:45], v17 offset:10240
    ds_read_b64_tr_b16 a[46:47], v17 offset:11264
    s_waitcnt lgkmcnt(0)
    s_add_u32 m0, s42, 10240
    s_add_u32 s43, s40, 745472
    buffer_load_dwordx4 v13, s[8:11], s43 offen lds
    buffer_load_dwordx4 v14, s[8:11], s43 offen offset:1024 lds
    s_waitcnt vmcnt(14)
    ds_read_b64_tr_b16 a[48:49], v16 offset:12288
    ds_read_b64_tr_b16 a[50:51], v16 offset:13312
    ds_read_b64_tr_b16 a[52:53], v17 offset:12288
    ds_read_b64_tr_b16 a[54:55], v17 offset:13312
    s_waitcnt lgkmcnt(0)
    s_add_u32 m0, s42, 12288
    s_add_u32 s43, s40, 802816
    buffer_load_dwordx4 v13, s[8:11], s43 offen lds
    buffer_load_dwordx4 v14, s[8:11], s43 offen offset:1024 lds
    s_waitcnt vmcnt(14)
    ds_read_b64_tr_b16 a[56:57], v16 offset:14336
    ds_read_b64_tr_b16 a[58:59], v16 offset:15360
    ds_read_b64_tr_b16 a[60:61], v17 offset:14336
    ds_read_b64_tr_b16 a[62:63], v17 offset:15360
    s_waitcnt lgkmcnt(0)
    s_add_u32 m0, s42, 14336
    s_add_u32 s43, s40, 860160
    buffer_load_dwordx4 v13, s[8:11], s43 offen lds
    buffer_load_dwordx4 v14, s[8:11], s43 offen offset:1024 lds
    s_waitcnt vmcnt(14)
    ds_read_b64_tr_b16 a[64:65], v16 offset:0
    ds_read_b64_tr_b16 a[66:67], v16 offset:1024
    ds_read_b64_tr_b16 a[68:69], v17 offset:0
    ds_read_b64_tr_b16 a[70:71], v17 offset:1024
    s_waitcnt lgkmcnt(0)
    s_add_u32 m0, s42, 0
    s_add_u32 s43, s40, 917504
    buffer_load_dwordx4 v13, s[8:11], s43 offen lds
    buffer_load_dwordx4 v14, s[8:11], s43 offen offset:1024 lds
    s_waitcnt vmcnt(14)
    ds_read_b64_tr_b16 a[72:73], v16 offset:2048
    ds_read_b64_tr_b16 a[74:75], v16 offset:3072
    ds_read_b64_tr_b16 a[76:77], v17 offset:2048
    ds_read_b64_tr_b16 a[78:79], v17 offset:3072
    s_waitcnt lgkmcnt(0)
    s_add_u32 m0, s42, 2048
    s_add_u32 s43, s40, 974848
    buffer_load_dwordx4 v13, s[8:11], s43 offen lds
    buffer_load_dwordx4 v14, s[8:11], s43 offen offset:1024 lds
    s_waitcnt vmcnt(14)
    ds_read_b64_tr_b16 a[80:81], v16 offset:4096
    ds_read_b64_tr_b16 a[82:83], v16 offset:5120
    ds_read_b64_tr_b16 a[84:85], v17 offset:4096
    ds_read_b64_tr_b16 a[86:87], v17 offset:5120
    s_waitcnt lgkmcnt(0)
    s_add_u32 m0, s42, 4096
    s_add_u32 s43, s40, 1032192
    buffer_load_dwordx4 v13, s[8:11], s43 offen lds
    buffer_load_dwordx4 v14, s[8:11], s43 offen offset:1024 lds
    s_waitcnt vmcnt(14)
    ds_read_b64_tr_b16 a[88:89], v16 offset:6144
    ds_read_b64_tr_b16 a[90:91], v16 offset:7168
    ds_read_b64_tr_b16 a[92:93], v17 offset:6144
    ds_read_b64_tr_b16 a[94:95], v17 offset:7168
    s_waitcnt lgkmcnt(0)
    s_add_u32 m0, s42, 6144
    s_add_u32 s43, s40, 1089536
    buffer_load_dwordx4 v13, s[8:11], s43 offen lds
    buffer_load_dwordx4 v14, s[8:11], s43 offen offset:1024 lds
    s_waitcnt vmcnt(14)
    ds_read_b64_tr_b16 a[96:97], v16 offset:8192
    ds_read_b64_tr_b16 a[98:99], v16 offset:9216
    ds_read_b64_tr_b16 a[100:101], v17 offset:8192
    ds_read_b64_tr_b16 a[102:103], v17 offset:9216
    s_waitcnt lgkmcnt(0)
    s_add_u32 m0, s42, 8192
    s_add_u32 s43, s40, 1146880
    buffer_load_dwordx4 v13, s[8:11], s43 offen lds
    buffer_load_dwordx4 v14, s[8:11], s43 offen offset:1024 lds
    s_waitcnt vmcnt(14)
    ds_read_b64_tr_b16 a[104:105], v16 offset:10240
    ds_read_b64_tr_b16 a[106:107], v16 offset:11264
    ds_read_b64_tr_b16 a[108:109], v17 offset:10240
    ds_read_b64_tr_b16 a[110:111], v17 offset:11264
    s_waitcnt lgkmcnt(0)
    s_add_u32 m0, s42, 10240
    s_add_u32 s43, s40, 1204224
    buffer_load_dwordx4 v13, s[8:11], s43 offen lds
    buffer_load_dwordx4 v14, s[8:11], s43 offen offset:1024 lds
    s_waitcnt vmcnt(14)
    ds_read_b64_tr_b16 a[112:113], v16 offset:12288
    ds_read_b64_tr_b16 a[114:115], v16 offset:13312
    ds_read_b64_tr_b16 a[116:117], v17 offset:12288
    ds_read_b64_tr_b16 a[118:119], v17 offset:13312
    s_waitcnt lgkmcnt(0)
    s_add_u32 m0, s42, 12288
    s_add_u32 s43, s40, 1261568
    buffer_load_dwordx4 v13, s[8:11], s43 offen lds
    buffer_load_dwordx4 v14, s[8:11], s43 offen offset:1024 lds
    s_waitcnt vmcnt(14)
    ds_read_b64_tr_b16 a[120:121], v16 offset:14336
    ds_read_b64_tr_b16 a[122:123], v16 offset:15360
    ds_read_b64_tr_b16 a[124:125], v17 offset:14336
    ds_read_b64_tr_b16 a[126:127], v17 offset:15360
    s_waitcnt lgkmcnt(0)
    s_add_u32 m0, s42, 14336
    s_add_u32 s43, s40, 1318912
    buffer_load_dwordx4 v13, s[8:11], s43 offen lds
    buffer_load_dwordx4 v14, s[8:11], s43 offen offset:1024 lds
    s_mov_b32 s16, s58
    s_and_b32 s17, s59, 0xffff
    s_mov_b32 s18, 3584
    s_mov_b32 s19, 0x20000
    v_lshrrev_b32 v3, 5, v2
    v_lshlrev_b32 v3, 3, v3
    s_lshl_b32 s39, s34, 6
    s_add_u32 s39, s38, s39
    buffer_load_dwordx2 v[24:25], v3, s[16:19], s39 offen offset:0
    buffer_load_dwordx2 v[26:27], v3, s[16:19], s39 offen offset:16
    buffer_load_dwordx2 v[28:29], v3, s[16:19], s39 offen offset:32
    buffer_load_dwordx2 v[30:31], v3, s[16:19], s39 offen offset:48
    s_mov_b64 exec, 1
    ds_add_u32 v8, v9 offset:76
    s_mov_b64 exec, -1
    s_mov_b32 s44, 524288
sp_58:
    ds_read_b32 v10, v8 offset:8
    s_waitcnt lgkmcnt(0)
    v_readfirstlane_b32 s45, v10
    s_sub_u32 s44, s44, 1
    s_cbranch_scc1 spe_59
    s_cmp_ge_u32 s45, 1
    s_cbranch_scc1 spe_59
    s_sleep 1
    s_branch sp_58
spe_59:
    s_add_u32 m0, s42, 16384
    s_add_u32 s43, s41, 32768
    buffer_load_dwordx4 v15, s[12:15], s43 offen sc1 lds
    buffer_load_dwordx4 v15, s[12:15], s43 offen offset:1024 sc1 lds
    s_add_u32 m0, s42, 18432
    s_add_u32 s43, s41, 34816
    buffer_load_dwordx4 v15, s[12:15], s43 offen sc1 lds
    buffer_load_dwordx4 v15, s[12:15], s43 offen offset:1024 sc1 lds
    s_add_u32 m0, s42, 20480
    s_add_u32 s43, s41, 36864
    buffer_load_dwordx4 v15, s[12:15], s43 offen sc1 lds
    buffer_load_dwordx4 v15, s[12:15], s43 offen offset:1024 sc1 lds
    s_add_u32 m0, s42, 22528
    s_add_u32 s43, s41, 38912
    buffer_load_dwordx4 v15, s[12:15], s43 offen sc1 lds
    buffer_load_dwordx4 v15, s[12:15], s43 offen offset:1024 sc1 lds
    s_add_u32 m0, s42, 24576
    s_add_u32 s43, s41, 40960
    buffer_load_dwordx4 v15, s[12:15], s43 offen sc1 lds
    buffer_load_dwordx4 v15, s[12:15], s43 offen offset:1024 sc1 lds
    s_add_u32 m0, s42, 26624
    s_add_u32 s43, s41, 43008
    buffer_load_dwordx4 v15, s[12:15], s43 offen sc1 lds
    buffer_load_dwordx4 v15, s[12:15], s43 offen offset:1024 sc1 lds
    s_add_u32 m0, s42, 28672
    s_add_u32 s43, s41, 45056
    buffer_load_dwordx4 v15, s[12:15], s43 offen sc1 lds
    buffer_load_dwordx4 v15, s[12:15], s43 offen offset:1024 sc1 lds
    s_waitcnt vmcnt(12)
    ds_read_b64_tr_b16 v[32:33], v16 offset:0
    ds_read_b64_tr_b16 v[34:35], v16 offset:1024
    ds_read_b64_tr_b16 v[36:37], v17 offset:0
    ds_read_b64_tr_b16 v[38:39], v17 offset:1024
    ds_read_b64_tr_b16 v[40:41], v18 offset:16384
    ds_read_b64_tr_b16 v[42:43], v18 offset:17408
    ds_read_b64_tr_b16 v[44:45], v19 offset:16384
    ds_read_b64_tr_b16 v[46:47], v19 offset:17408
    s_waitcnt vmcnt(10)
    ds_read_b64_tr_b16 v[48:49], v16 offset:2048
    ds_read_b64_tr_b16 v[50:51], v16 offset:3072
    ds_read_b64_tr_b16 v[52:53], v17 offset:2048
    ds_read_b64_tr_b16 v[54:55], v17 offset:3072
    ds_read_b64_tr_b16 v[56:57], v18 offset:18432
    ds_read_b64_tr_b16 v[58:59], v18 offset:19456
    ds_read_b64_tr_b16 v[60:61], v19 offset:18432
    ds_read_b64_tr_b16 v[62:63], v19 offset:19456
    s_waitcnt lgkmcnt(8)
    v_mfma_f32_32x32x16_bf16 v[64:79], v[32:35], v[40:43], 0
    s_add_u32 m0, s42, 30720
    s_add_u32 s43, s41, 47104
    buffer_load_dwordx4 v15, s[12:15], s43 offen sc1 lds
    v_mfma_f32_32x32x16_bf16 v[80:95], v[32:35], v[44:47], 0
    buffer_load_dwordx4 v15, s[12:15], s43 offen offset:1024 sc1 lds
    v_mfma_f32_32x32x16_bf16 v[96:111], v[36:39], v[40:43], 0
    v_mfma_f32_32x32x16_bf16 v[112:127], v[36:39], v[44:47], 0
    s_waitcnt vmcnt(10)
    ds_read_b64_tr_b16 v[32:33], v16 offset:4096
    ds_read_b64_tr_b16 v[34:35], v16 offset:5120
    ds_read_b64_tr_b16 v[36:37], v17 offset:4096
    ds_read_b64_tr_b16 v[38:39], v17 offset:5120
    ds_read_b64_tr_b16 v[40:41], v18 offset:20480
    ds_read_b64_tr_b16 v[42:43], v18 offset:21504
    ds_read_b64_tr_b16 v[44:45], v19 offset:20480
    ds_read_b64_tr_b16 v[46:47], v19 offset:21504
    s_waitcnt lgkmcnt(8)
    v_mfma_f32_32x32x16_bf16 v[64:79], v[48:51], v[56:59], v[64:79]
    s_add_u32 m0, s42, 16384
    s_add_u32 s43, s41, 49152
    buffer_load_dwordx4 v15, s[12:15], s43 offen sc1 lds
    v_mfma_f32_32x32x16_bf16 v[80:95], v[48:51], v[60:63], v[80:95]
    buffer_load_dwordx4 v15, s[12:15], s43 offen offset:1024 sc1 lds
    v_mfma_f32_32x32x16_bf16 v[96:111], v[52:55], v[56:59], v[96:111]
    s_add_u32 m0, s42, 0
    s_add_u32 s43, s40, 1376256
    buffer_load_dwordx4 v13, s[8:11], s43 offen lds
    v_mfma_f32_32x32x16_bf16 v[112:127], v[52:55], v[60:63], v[112:127]
    buffer_load_dwordx4 v14, s[8:11], s43 offen offset:1024 lds
    s_waitcnt vmcnt(12)
    ds_read_b64_tr_b16 v[48:49], v16 offset:6144
    ds_read_b64_tr_b16 v[50:51], v16 offset:7168
    ds_read_b64_tr_b16 v[52:53], v17 offset:6144
    ds_read_b64_tr_b16 v[54:55], v17 offset:7168
    ds_read_b64_tr_b16 v[56:57], v18 offset:22528
    ds_read_b64_tr_b16 v[58:59], v18 offset:23552
    ds_read_b64_tr_b16 v[60:61], v19 offset:22528
    ds_read_b64_tr_b16 v[62:63], v19 offset:23552
    s_waitcnt lgkmcnt(8)
    v_mfma_f32_32x32x16_bf16 v[64:79], v[32:35], v[40:43], v[64:79]
    s_add_u32 m0, s42, 18432
    s_add_u32 s43, s41, 51200
    buffer_load_dwordx4 v15, s[12:15], s43 offen sc1 lds
    v_mfma_f32_32x32x16_bf16 v[80:95], v[32:35], v[44:47], v[80:95]
    buffer_load_dwordx4 v15, s[12:15], s43 offen offset:1024 sc1 lds
    v_mfma_f32_32x32x16_bf16 v[96:111], v[36:39], v[40:43], v[96:111]
    s_add_u32 m0, s42, 2048
    s_add_u32 s43, s40, 1433600
    buffer_load_dwordx4 v13, s[8:11], s43 offen lds
    v_mfma_f32_32x32x16_bf16 v[112:127], v[36:39], v[44:47], v[112:127]
    buffer_load_dwordx4 v14, s[8:11], s43 offen offset:1024 lds
    s_waitcnt vmcnt(14)
    ds_read_b64_tr_b16 v[32:33], v16 offset:8192
    ds_read_b64_tr_b16 v[34:35], v16 offset:9216
    ds_read_b64_tr_b16 v[36:37], v17 offset:8192
    ds_read_b64_tr_b16 v[38:39], v17 offset:9216
    ds_read_b64_tr_b16 v[40:41], v18 offset:24576
    ds_read_b64_tr_b16 v[42:43], v18 offset:25600
    ds_read_b64_tr_b16 v[44:45], v19 offset:24576
    ds_read_b64_tr_b16 v[46:47], v19 offset:25600
    s_waitcnt lgkmcnt(8)
    v_mfma_f32_32x32x16_bf16 v[64:79], v[48:51], v[56:59], v[64:79]
    s_add_u32 m0, s42, 20480
    s_add_u32 s43, s41, 53248
    buffer_load_dwordx4 v15, s[12:15], s43 offen sc1 lds
    v_mfma_f32_32x32x16_bf16 v[80:95], v[48:51], v[60:63], v[80:95]
    buffer_load_dwordx4 v15, s[12:15], s43 offen offset:1024 sc1 lds
    v_mfma_f32_32x32x16_bf16 v[96:111], v[52:55], v[56:59], v[96:111]
    s_add_u32 m0, s42, 4096
    s_add_u32 s43, s40, 1490944
    buffer_load_dwordx4 v13, s[8:11], s43 offen lds
    v_mfma_f32_32x32x16_bf16 v[112:127], v[52:55], v[60:63], v[112:127]
    buffer_load_dwordx4 v14, s[8:11], s43 offen offset:1024 lds
    s_waitcnt vmcnt(16)
    ds_read_b64_tr_b16 v[48:49], v16 offset:10240
    ds_read_b64_tr_b16 v[50:51], v16 offset:11264
    ds_read_b64_tr_b16 v[52:53], v17 offset:10240
    ds_read_b64_tr_b16 v[54:55], v17 offset:11264
    ds_read_b64_tr_b16 v[56:57], v18 offset:26624
    ds_read_b64_tr_b16 v[58:59], v18 offset:27648
    ds_read_b64_tr_b16 v[60:61], v19 offset:26624
    ds_read_b64_tr_b16 v[62:63], v19 offset:27648
    s_waitcnt lgkmcnt(8)
    v_mfma_f32_32x32x16_bf16 v[64:79], v[32:35], v[40:43], v[64:79]
    s_add_u32 m0, s42, 22528
    s_add_u32 s43, s41, 55296
    buffer_load_dwordx4 v15, s[12:15], s43 offen sc1 lds
    v_mfma_f32_32x32x16_bf16 v[80:95], v[32:35], v[44:47], v[80:95]
    buffer_load_dwordx4 v15, s[12:15], s43 offen offset:1024 sc1 lds
    v_mfma_f32_32x32x16_bf16 v[96:111], v[36:39], v[40:43], v[96:111]
    s_add_u32 m0, s42, 6144
    s_add_u32 s43, s40, 1548288
    buffer_load_dwordx4 v13, s[8:11], s43 offen lds
    v_mfma_f32_32x32x16_bf16 v[112:127], v[36:39], v[44:47], v[112:127]
    buffer_load_dwordx4 v14, s[8:11], s43 offen offset:1024 lds
    s_waitcnt vmcnt(18)
    ds_read_b64_tr_b16 v[32:33], v16 offset:12288
    ds_read_b64_tr_b16 v[34:35], v16 offset:13312
    ds_read_b64_tr_b16 v[36:37], v17 offset:12288
    ds_read_b64_tr_b16 v[38:39], v17 offset:13312
    ds_read_b64_tr_b16 v[40:41], v18 offset:28672
    ds_read_b64_tr_b16 v[42:43], v18 offset:29696
    ds_read_b64_tr_b16 v[44:45], v19 offset:28672
    ds_read_b64_tr_b16 v[46:47], v19 offset:29696
    s_waitcnt lgkmcnt(8)
    v_mfma_f32_32x32x16_bf16 v[64:79], v[48:51], v[56:59], v[64:79]
    s_add_u32 m0, s42, 24576
    s_add_u32 s43, s41, 57344
    buffer_load_dwordx4 v15, s[12:15], s43 offen sc1 lds
    v_mfma_f32_32x32x16_bf16 v[80:95], v[48:51], v[60:63], v[80:95]
    buffer_load_dwordx4 v15, s[12:15], s43 offen offset:1024 sc1 lds
    v_mfma_f32_32x32x16_bf16 v[96:111], v[52:55], v[56:59], v[96:111]
    s_add_u32 m0, s42, 8192
    s_add_u32 s43, s40, 1605632
    buffer_load_dwordx4 v13, s[8:11], s43 offen lds
    v_mfma_f32_32x32x16_bf16 v[112:127], v[52:55], v[60:63], v[112:127]
    buffer_load_dwordx4 v14, s[8:11], s43 offen offset:1024 lds
    s_waitcnt vmcnt(20)
    ds_read_b64_tr_b16 v[48:49], v16 offset:14336
    ds_read_b64_tr_b16 v[50:51], v16 offset:15360
    ds_read_b64_tr_b16 v[52:53], v17 offset:14336
    ds_read_b64_tr_b16 v[54:55], v17 offset:15360
    ds_read_b64_tr_b16 v[56:57], v18 offset:30720
    ds_read_b64_tr_b16 v[58:59], v18 offset:31744
    ds_read_b64_tr_b16 v[60:61], v19 offset:30720
    ds_read_b64_tr_b16 v[62:63], v19 offset:31744
    s_waitcnt lgkmcnt(8)
    v_mfma_f32_32x32x16_bf16 v[64:79], v[32:35], v[40:43], v[64:79]
    s_add_u32 m0, s42, 26624
    s_add_u32 s43, s41, 59392
    buffer_load_dwordx4 v15, s[12:15], s43 offen sc1 lds
    v_mfma_f32_32x32x16_bf16 v[80:95], v[32:35], v[44:47], v[80:95]
    buffer_load_dwordx4 v15, s[12:15], s43 offen offset:1024 sc1 lds
    v_mfma_f32_32x32x16_bf16 v[96:111], v[36:39], v[40:43], v[96:111]
    s_add_u32 m0, s42, 10240
    s_add_u32 s43, s40, 1662976
    buffer_load_dwordx4 v13, s[8:11], s43 offen lds
    v_mfma_f32_32x32x16_bf16 v[112:127], v[36:39], v[44:47], v[112:127]
    buffer_load_dwordx4 v14, s[8:11], s43 offen offset:1024 lds
    s_waitcnt vmcnt(20)
    ds_read_b64_tr_b16 v[32:33], v16 offset:0
    ds_read_b64_tr_b16 v[34:35], v16 offset:1024
    ds_read_b64_tr_b16 v[36:37], v17 offset:0
    ds_read_b64_tr_b16 v[38:39], v17 offset:1024
    ds_read_b64_tr_b16 v[40:41], v18 offset:16384
    ds_read_b64_tr_b16 v[42:43], v18 offset:17408
    ds_read_b64_tr_b16 v[44:45], v19 offset:16384
    ds_read_b64_tr_b16 v[46:47], v19 offset:17408
    s_waitcnt lgkmcnt(8)
    v_mfma_f32_32x32x16_bf16 v[64:79], v[48:51], v[56:59], v[64:79]
    s_add_u32 m0, s42, 28672
    s_add_u32 s43, s41, 61440
    buffer_load_dwordx4 v15, s[12:15], s43 offen sc1 lds
    v_mfma_f32_32x32x16_bf16 v[80:95], v[48:51], v[60:63], v[80:95]
    buffer_load_dwordx4 v15, s[12:15], s43 offen offset:1024 sc1 lds
    v_mfma_f32_32x32x16_bf16 v[96:111], v[52:55], v[56:59], v[96:111]
    s_add_u32 m0, s42, 12288
    s_add_u32 s43, s40, 1720320
    buffer_load_dwordx4 v13, s[8:11], s43 offen lds
    v_mfma_f32_32x32x16_bf16 v[112:127], v[52:55], v[60:63], v[112:127]
    buffer_load_dwordx4 v14, s[8:11], s43 offen offset:1024 lds
    s_waitcnt vmcnt(20)
    ds_read_b64_tr_b16 v[48:49], v16 offset:2048
    ds_read_b64_tr_b16 v[50:51], v16 offset:3072
    ds_read_b64_tr_b16 v[52:53], v17 offset:2048
    ds_read_b64_tr_b16 v[54:55], v17 offset:3072
    ds_read_b64_tr_b16 v[56:57], v18 offset:18432
    ds_read_b64_tr_b16 v[58:59], v18 offset:19456
    ds_read_b64_tr_b16 v[60:61], v19 offset:18432
    ds_read_b64_tr_b16 v[62:63], v19 offset:19456
    s_waitcnt lgkmcnt(8)
    v_mfma_f32_32x32x16_bf16 v[64:79], v[32:35], v[40:43], v[64:79]
    s_add_u32 m0, s42, 30720
    s_add_u32 s43, s41, 63488
    buffer_load_dwordx4 v15, s[12:15], s43 offen sc1 lds
    v_mfma_f32_32x32x16_bf16 v[80:95], v[32:35], v[44:47], v[80:95]
    buffer_load_dwordx4 v15, s[12:15], s43 offen offset:1024 sc1 lds
    v_mfma_f32_32x32x16_bf16 v[96:111], v[36:39], v[40:43], v[96:111]
    s_add_u32 m0, s42, 14336
    s_add_u32 s43, s40, 1777664
    buffer_load_dwordx4 v13, s[8:11], s43 offen lds
    v_mfma_f32_32x32x16_bf16 v[112:127], v[36:39], v[44:47], v[112:127]
    buffer_load_dwordx4 v14, s[8:11], s43 offen offset:1024 lds
    s_waitcnt vmcnt(20)
    ds_read_b64_tr_b16 v[32:33], v16 offset:4096
    ds_read_b64_tr_b16 v[34:35], v16 offset:5120
    ds_read_b64_tr_b16 v[36:37], v17 offset:4096
    ds_read_b64_tr_b16 v[38:39], v17 offset:5120
    ds_read_b64_tr_b16 v[40:41], v18 offset:20480
    ds_read_b64_tr_b16 v[42:43], v18 offset:21504
    ds_read_b64_tr_b16 v[44:45], v19 offset:20480
    ds_read_b64_tr_b16 v[46:47], v19 offset:21504
    s_waitcnt lgkmcnt(8)
    v_mfma_f32_32x32x16_bf16 v[64:79], v[48:51], v[56:59], v[64:79]
    s_add_u32 m0, s42, 16384
    s_add_u32 s43, s41, 0
    buffer_load_dwordx4 v15, s[12:15], s43 offen sc1 lds
    v_mfma_f32_32x32x16_bf16 v[80:95], v[48:51], v[60:63], v[80:95]
    buffer_load_dwordx4 v15, s[12:15], s43 offen offset:1024 sc1 lds
    v_mfma_f32_32x32x16_bf16 v[96:111], v[52:55], v[56:59], v[96:111]
    v_mfma_f32_32x32x16_bf16 v[112:127], v[52:55], v[60:63], v[112:127]
    s_waitcnt vmcnt(18)
    ds_read_b64_tr_b16 v[48:49], v16 offset:6144
    ds_read_b64_tr_b16 v[50:51], v16 offset:7168
    ds_read_b64_tr_b16 v[52:53], v17 offset:6144
    ds_read_b64_tr_b16 v[54:55], v17 offset:7168
    ds_read_b64_tr_b16 v[56:57], v18 offset:22528
    ds_read_b64_tr_b16 v[58:59], v18 offset:23552
    ds_read_b64_tr_b16 v[60:61], v19 offset:22528
    ds_read_b64_tr_b16 v[62:63], v19 offset:23552
    s_waitcnt lgkmcnt(8)
    v_mfma_f32_32x32x16_bf16 v[64:79], v[32:35], v[40:43], v[64:79]
    s_add_u32 m0, s42, 18432
    s_add_u32 s43, s41, 2048
    buffer_load_dwordx4 v15, s[12:15], s43 offen sc1 lds
    v_mfma_f32_32x32x16_bf16 v[80:95], v[32:35], v[44:47], v[80:95]
    buffer_load_dwordx4 v15, s[12:15], s43 offen offset:1024 sc1 lds
    v_mfma_f32_32x32x16_bf16 v[96:111], v[36:39], v[40:43], v[96:111]
    v_mfma_f32_32x32x16_bf16 v[112:127], v[36:39], v[44:47], v[112:127]
    s_waitcnt vmcnt(16)
    ds_read_b64_tr_b16 v[32:33], v16 offset:8192
    ds_read_b64_tr_b16 v[34:35], v16 offset:9216
    ds_read_b64_tr_b16 v[36:37], v17 offset:8192
    ds_read_b64_tr_b16 v[38:39], v17 offset:9216
    ds_read_b64_tr_b16 v[40:41], v18 offset:24576
    ds_read_b64_tr_b16 v[42:43], v18 offset:25600
    ds_read_b64_tr_b16 v[44:45], v19 offset:24576
    ds_read_b64_tr_b16 v[46:47], v19 offset:25600
    s_waitcnt lgkmcnt(8)
    v_mfma_f32_32x32x16_bf16 v[64:79], v[48:51], v[56:59], v[64:79]
    s_add_u32 m0, s42, 20480
    s_add_u32 s43, s41, 4096
    buffer_load_dwordx4 v15, s[12:15], s43 offen sc1 lds
    v_mfma_f32_32x32x16_bf16 v[80:95], v[48:51], v[60:63], v[80:95]
    buffer_load_dwordx4 v15, s[12:15], s43 offen offset:1024 sc1 lds
    v_mfma_f32_32x32x16_bf16 v[96:111], v[52:55], v[56:59], v[96:111]
    v_mfma_f32_32x32x16_bf16 v[112:127], v[52:55], v[60:63], v[112:127]
    s_waitcnt vmcnt(14)
    ds_read_b64_tr_b16 v[48:49], v16 offset:10240
    ds_read_b64_tr_b16 v[50:51], v16 offset:11264
    ds_read_b64_tr_b16 v[52:53], v17 offset:10240
    ds_read_b64_tr_b16 v[54:55], v17 offset:11264
    ds_read_b64_tr_b16 v[56:57], v18 offset:26624
    ds_read_b64_tr_b16 v[58:59], v18 offset:27648
    ds_read_b64_tr_b16 v[60:61], v19 offset:26624
    ds_read_b64_tr_b16 v[62:63], v19 offset:27648
    s_waitcnt lgkmcnt(8)
    s_mul_i32 s39, s24, 229376
    s_lshl_b32 s27, s25, 13
    s_add_u32 s39, s39, s27
    s_lshl_b32 s27, s34, 12
    s_add_u32 s39, s39, s27
    s_lshl_b32 s27, s35, 10
    s_add_u32 s39, s39, s27
    s_add_u32 s39, s39, 11534336
    s_lshl_b32 s36, s24, 5
    s_add_u32 s36, s36, s25
    s_lshl_b32 s36, s36, 2
    s_lshl_b32 s24, s22, 2
    s_and_b32 s25, s23, 3
    s_add_u32 s24, s24, s25
    s_lshr_b32 s25, s23, 2
    v_lshrrev_b32 v3, 3, v2
    v_bfe_u32 v4, v2, 4, 1
    v_lshlrev_b32 v4, 2, v4
    v_xor_b32 v4, v4, v2
    v_and_b32 v4, 7, v4
    v_lshlrev_b32 v4, 4, v4
    v_lshl_add_u32 v13, v3, 12, v4
    s_lshl_b32 s27, s24, 7
    v_add_u32 v13, s27, v13
    v_add_u32 v14, 31744, v13
    s_mul_i32 s40, s3, 1835008
    s_mul_i32 s33, s25, 229376
    s_mul_i32 s27, s3, 57344
    s_add_u32 s33, s33, s27
    s_add_u32 s33, s33, 11534336
    s_lshl_b32 s27, s34, 10
    v_xor_b32 v6, s27, v5
    v_xor_b32 v7, 0x400, v6
    s_mov_b32 s8, s60
    s_and_b32 s9, s61, 0xffff
    s_mov_b32 s10, 7340032
    s_mov_b32 s11, 0x20000
    v_mfma_f32_32x32x16_bf16 v[64:79], v[32:35], v[40:43], v[64:79]
    s_add_u32 m0, s42, 22528
    s_add_u32 s43, s41, 6144
    buffer_load_dwordx4 v15, s[12:15], s43 offen sc1 lds
    v_mfma_f32_32x32x16_bf16 v[80:95], v[32:35], v[44:47], v[80:95]
    buffer_load_dwordx4 v15, s[12:15], s43 offen offset:1024 sc1 lds
    v_mfma_f32_32x32x16_bf16 v[96:111], v[36:39], v[40:43], v[96:111]
    v_mfma_f32_32x32x16_bf16 v[112:127], v[36:39], v[44:47], v[112:127]
    s_waitcnt vmcnt(12)
    ds_read_b64_tr_b16 v[32:33], v16 offset:12288
    ds_read_b64_tr_b16 v[34:35], v16 offset:13312
    ds_read_b64_tr_b16 v[36:37], v17 offset:12288
    ds_read_b64_tr_b16 v[38:39], v17 offset:13312
    ds_read_b64_tr_b16 v[40:41], v18 offset:28672
    ds_read_b64_tr_b16 v[42:43], v18 offset:29696
    ds_read_b64_tr_b16 v[44:45], v19 offset:28672
    ds_read_b64_tr_b16 v[46:47], v19 offset:29696
    s_waitcnt lgkmcnt(8)
    v_mfma_f32_32x32x16_bf16 v[64:79], v[48:51], v[56:59], v[64:79]
    s_add_u32 m0, s42, 24576
    s_add_u32 s43, s41, 8192
    buffer_load_dwordx4 v15, s[12:15], s43 offen sc1 lds
    v_mfma_f32_32x32x16_bf16 v[80:95], v[48:51], v[60:63], v[80:95]
    buffer_load_dwordx4 v15, s[12:15], s43 offen offset:1024 sc1 lds
    v_mfma_f32_32x32x16_bf16 v[96:111], v[52:55], v[56:59], v[96:111]
    v_mfma_f32_32x32x16_bf16 v[112:127], v[52:55], v[60:63], v[112:127]
    s_waitcnt vmcnt(10)
    ds_read_b64_tr_b16 v[48:49], v16 offset:14336
    ds_read_b64_tr_b16 v[50:51], v16 offset:15360
    ds_read_b64_tr_b16 v[52:53], v17 offset:14336
    ds_read_b64_tr_b16 v[54:55], v17 offset:15360
    ds_read_b64_tr_b16 v[56:57], v18 offset:30720
    ds_read_b64_tr_b16 v[58:59], v18 offset:31744
    ds_read_b64_tr_b16 v[60:61], v19 offset:30720
    ds_read_b64_tr_b16 v[62:63], v19 offset:31744
    s_waitcnt lgkmcnt(8)
    v_mfma_f32_32x32x16_bf16 v[64:79], v[32:35], v[40:43], v[64:79]
    s_add_u32 m0, s42, 26624
    s_add_u32 s43, s41, 10240
    buffer_load_dwordx4 v15, s[12:15], s43 offen sc1 lds
    v_mfma_f32_32x32x16_bf16 v[80:95], v[32:35], v[44:47], v[80:95]
    buffer_load_dwordx4 v15, s[12:15], s43 offen offset:1024 sc1 lds
    v_mfma_f32_32x32x16_bf16 v[96:111], v[36:39], v[40:43], v[96:111]
    v_mfma_f32_32x32x16_bf16 v[112:127], v[36:39], v[44:47], v[112:127]
    s_waitcnt vmcnt(10)
    ds_read_b64_tr_b16 v[40:41], v18 offset:16384
    ds_read_b64_tr_b16 v[42:43], v18 offset:17408
    ds_read_b64_tr_b16 v[44:45], v19 offset:16384
    ds_read_b64_tr_b16 v[46:47], v19 offset:17408
    s_waitcnt lgkmcnt(4)
    v_mfma_f32_32x32x16_bf16 v[64:79], v[48:51], v[56:59], v[64:79]
    s_add_u32 m0, s42, 28672
    s_add_u32 s43, s41, 12288
    buffer_load_dwordx4 v15, s[12:15], s43 offen sc1 lds
    v_mfma_f32_32x32x16_bf16 v[80:95], v[48:51], v[60:63], v[80:95]
    buffer_load_dwordx4 v15, s[12:15], s43 offen offset:1024 sc1 lds
    v_mfma_f32_32x32x16_bf16 v[96:111], v[52:55], v[56:59], v[96:111]
    v_mfma_f32_32x32x16_bf16 v[112:127], v[52:55], v[60:63], v[112:127]
    s_waitcnt vmcnt(10)
    ds_read_b64_tr_b16 v[56:57], v18 offset:18432
    ds_read_b64_tr_b16 v[58:59], v18 offset:19456
    ds_read_b64_tr_b16 v[60:61], v19 offset:18432
    ds_read_b64_tr_b16 v[62:63], v19 offset:19456
    s_waitcnt lgkmcnt(4)
    v_mfma_f32_32x32x16_bf16 v[64:79], a[0:3], v[40:43], v[64:79]
    s_add_u32 m0, s42, 30720
    s_add_u32 s43, s41, 14336
    buffer_load_dwordx4 v15, s[12:15], s43 offen sc1 lds
    v_mfma_f32_32x32x16_bf16 v[80:95], a[0:3], v[44:47], v[80:95]
    buffer_load_dwordx4 v15, s[12:15], s43 offen offset:1024 sc1 lds
    v_mfma_f32_32x32x16_bf16 v[96:111], a[4:7], v[40:43], v[96:111]
    v_mfma_f32_32x32x16_bf16 v[112:127], a[4:7], v[44:47], v[112:127]
    s_waitcnt vmcnt(10)
    ds_read_b64_tr_b16 v[40:41], v18 offset:20480
    ds_read_b64_tr_b16 v[42:43], v18 offset:21504
    ds_read_b64_tr_b16 v[44:45], v19 offset:20480
    ds_read_b64_tr_b16 v[46:47], v19 offset:21504
    s_waitcnt lgkmcnt(4)
    v_mfma_f32_32x32x16_bf16 v[64:79], a[8:11], v[56:59], v[64:79]
    s_add_u32 m0, s42, 16384
    s_add_u32 s43, s41, 16384
    buffer_load_dwordx4 v15, s[12:15], s43 offen sc1 lds
    v_mfma_f32_32x32x16_bf16 v[80:95], a[8:11], v[60:63], v[80:95]
    buffer_load_dwordx4 v15, s[12:15], s43 offen offset:1024 sc1 lds
    v_mfma_f32_32x32x16_bf16 v[96:111], a[12:15], v[56:59], v[96:111]
    v_mfma_f32_32x32x16_bf16 v[112:127], a[12:15], v[60:63], v[112:127]
    s_waitcnt vmcnt(10)
    ds_read_b64_tr_b16 v[56:57], v18 offset:22528
    ds_read_b64_tr_b16 v[58:59], v18 offset:23552
    ds_read_b64_tr_b16 v[60:61], v19 offset:22528
    ds_read_b64_tr_b16 v[62:63], v19 offset:23552
    s_waitcnt lgkmcnt(4)
    v_mfma_f32_32x32x16_bf16 v[64:79], a[16:19], v[40:43], v[64:79]
    s_add_u32 m0, s42, 18432
    s_add_u32 s43, s41, 18432
    buffer_load_dwordx4 v15, s[12:15], s43 offen sc1 lds
    v_mfma_f32_32x32x16_bf16 v[80:95], a[16:19], v[44:47], v[80:95]
    buffer_load_dwordx4 v15, s[12:15], s43 offen offset:1024 sc1 lds
    v_mfma_f32_32x32x16_bf16 v[96:111], a[20:23], v[40:43], v[96:111]
    v_mfma_f32_32x32x16_bf16 v[112:127], a[20:23], v[44:47], v[112:127]
    s_waitcnt vmcnt(10)
    ds_read_b64_tr_b16 v[40:41], v18 offset:24576
    ds_read_b64_tr_b16 v[42:43], v18 offset:25600
    ds_read_b64_tr_b16 v[44:45], v19 offset:24576
    ds_read_b64_tr_b16 v[46:47], v19 offset:25600
    s_waitcnt lgkmcnt(4)
    v_mfma_f32_32x32x16_bf16 v[64:79], a[24:27], v[56:59], v[64:79]
    s_add_u32 m0, s42, 20480
    s_add_u32 s43, s41, 20480
    buffer_load_dwordx4 v15, s[12:15], s43 offen sc1 lds
    v_mfma_f32_32x32x16_bf16 v[80:95], a[24:27], v[60:63], v[80:95]
    buffer_load_dwordx4 v15, s[12:15], s43 offen offset:1024 sc1 lds
    v_mfma_f32_32x32x16_bf16 v[96:111], a[28:31], v[56:59], v[96:111]
    v_mfma_f32_32x32x16_bf16 v[112:127], a[28:31], v[60:63], v[112:127]
    s_waitcnt vmcnt(10)
    ds_read_b64_tr_b16 v[56:57], v18 offset:26624
    ds_read_b64_tr_b16 v[58:59], v18 offset:27648
    ds_read_b64_tr_b16 v[60:61], v19 offset:26624
    ds_read_b64_tr_b16 v[62:63], v19 offset:27648
    s_waitcnt lgkmcnt(4)
    v_mfma_f32_32x32x16_bf16 v[64:79], a[32:35], v[40:43], v[64:79]
    s_add_u32 m0, s42, 22528
    s_add_u32 s43, s41, 22528
    buffer_load_dwordx4 v15, s[12:15], s43 offen sc1 lds
    v_mfma_f32_32x32x16_bf16 v[80:95], a[32:35], v[44:47], v[80:95]
    buffer_load_dwordx4 v15, s[12:15], s43 offen offset:1024 sc1 lds
    v_mfma_f32_32x32x16_bf16 v[96:111], a[36:39], v[40:43], v[96:111]
    s_add_u32 m0, s42, 0
    s_add_u32 s43, s40, 0
    buffer_load_dwordx4 v13, s[8:11], s43 offen lds
    v_mfma_f32_32x32x16_bf16 v[112:127], a[36:39], v[44:47], v[112:127]
    buffer_load_dwordx4 v14, s[8:11], s43 offen offset:1024 lds
    s_waitcnt vmcnt(12)
    ds_read_b64_tr_b16 v[40:41], v18 offset:28672
    ds_read_b64_tr_b16 v[42:43], v18 offset:29696
    ds_read_b64_tr_b16 v[44:45], v19 offset:28672
    ds_read_b64_tr_b16 v[46:47], v19 offset:29696
    s_waitcnt lgkmcnt(4)
    v_mfma_f32_32x32x16_bf16 v[64:79], a[40:43], v[56:59], v[64:79]
    s_add_u32 m0, s42, 24576
    s_add_u32 s43, s41, 24576
    buffer_load_dwordx4 v15, s[12:15], s43 offen sc1 lds
    v_mfma_f32_32x32x16_bf16 v[80:95], a[40:43], v[60:63], v[80:95]
    buffer_load_dwordx4 v15, s[12:15], s43 offen offset:1024 sc1 lds
    v_mfma_f32_32x32x16_bf16 v[96:111], a[44:47], v[56:59], v[96:111]
    s_add_u32 m0, s42, 2048
    s_add_u32 s43, s40, 65536
    buffer_load_dwordx4 v13, s[8:11], s43 offen lds
    v_mfma_f32_32x32x16_bf16 v[112:127], a[44:47], v[60:63], v[112:127]
    buffer_load_dwordx4 v14, s[8:11], s43 offen offset:1024 lds
    s_waitcnt vmcnt(14)
    ds_read_b64_tr_b16 v[56:57], v18 offset:30720
    ds_read_b64_tr_b16 v[58:59], v18 offset:31744
    ds_read_b64_tr_b16 v[60:61], v19 offset:30720
    ds_read_b64_tr_b16 v[62:63], v19 offset:31744
    s_waitcnt lgkmcnt(4)
    v_mfma_f32_32x32x16_bf16 v[64:79], a[48:51], v[40:43], v[64:79]
    s_add_u32 m0, s42, 26624
    s_add_u32 s43, s41, 26624
    buffer_load_dwordx4 v15, s[12:15], s43 offen sc1 lds
    v_mfma_f32_32x32x16_bf16 v[80:95], a[48:51], v[44:47], v[80:95]
    buffer_load_dwordx4 v15, s[12:15], s43 offen offset:1024 sc1 lds
    v_mfma_f32_32x32x16_bf16 v[96:111], a[52:55], v[40:43], v[96:111]
    s_add_u32 m0, s42, 4096
    s_add_u32 s43, s40, 131072
    buffer_load_dwordx4 v13, s[8:11], s43 offen lds
    v_mfma_f32_32x32x16_bf16 v[112:127], a[52:55], v[44:47], v[112:127]
    buffer_load_dwordx4 v14, s[8:11], s43 offen offset:1024 lds
    s_waitcnt vmcnt(16)
    ds_read_b64_tr_b16 v[40:41], v18 offset:16384
    ds_read_b64_tr_b16 v[42:43], v18 offset:17408
    ds_read_b64_tr_b16 v[44:45], v19 offset:16384
    ds_read_b64_tr_b16 v[46:47], v19 offset:17408
    s_waitcnt lgkmcnt(4)
    v_mfma_f32_32x32x16_bf16 v[64:79], a[56:59], v[56:59], v[64:79]
    s_add_u32 m0, s42, 28672
    s_add_u32 s43, s41, 28672
    buffer_load_dwordx4 v15, s[12:15], s43 offen sc1 lds
    v_mfma_f32_32x32x16_bf16 v[80:95], a[56:59], v[60:63], v[80:95]
    buffer_load_dwordx4 v15, s[12:15], s43 offen offset:1024 sc1 lds
    v_mfma_f32_32x32x16_bf16 v[96:111], a[60:63], v[56:59], v[96:111]
    s_add_u32 m0, s42, 6144
    s_add_u32 s43, s40, 196608
    buffer_load_dwordx4 v13, s[8:11], s43 offen lds
    v_mfma_f32_32x32x16_bf16 v[112:127], a[60:63], v[60:63], v[112:127]
    buffer_load_dwordx4 v14, s[8:11], s43 offen offset:1024 lds
    s_waitcnt vmcnt(18)
    ds_read_b64_tr_b16 v[56:57], v18 offset:18432
    ds_read_b64_tr_b16 v[58:59], v18 offset:19456
    ds_read_b64_tr_b16 v[60:61], v19 offset:18432
    ds_read_b64_tr_b16 v[62:63], v19 offset:19456
    s_waitcnt lgkmcnt(4)
    v_mfma_f32_32x32x16_bf16 v[64:79], a[64:67], v[40:43], v[64:79]
    s_add_u32 m0, s42, 30720
    s_add_u32 s43, s41, 30720
    buffer_load_dwordx4 v15, s[12:15], s43 offen sc1 lds
    v_mfma_f32_32x32x16_bf16 v[80:95], a[64:67], v[44:47], v[80:95]
    buffer_load_dwordx4 v15, s[12:15], s43 offen offset:1024 sc1 lds
    v_mfma_f32_32x32x16_bf16 v[96:111], a[68:71], v[40:43], v[96:111]
    s_add_u32 m0, s42, 8192
    s_add_u32 s43, s40, 262144
    buffer_load_dwordx4 v13, s[8:11], s43 offen lds
    v_mfma_f32_32x32x16_bf16 v[112:127], a[68:71], v[44:47], v[112:127]
    buffer_load_dwordx4 v14, s[8:11], s43 offen offset:1024 lds
    s_waitcnt vmcnt(20)
    ds_read_b64_tr_b16 v[40:41], v18 offset:20480
    ds_read_b64_tr_b16 v[42:43], v18 offset:21504
    ds_read_b64_tr_b16 v[44:45], v19 offset:20480
    ds_read_b64_tr_b16 v[46:47], v19 offset:21504
    s_waitcnt lgkmcnt(4)
    v_mfma_f32_32x32x16_bf16 v[64:79], a[72:75], v[56:59], v[64:79]
    v_mfma_f32_32x32x16_bf16 v[80:95], a[72:75], v[60:63], v[80:95]
    v_mfma_f32_32x32x16_bf16 v[96:111], a[76:79], v[56:59], v[96:111]
    s_add_u32 m0, s42, 10240
    s_add_u32 s43, s40, 327680
    buffer_load_dwordx4 v13, s[8:11], s43 offen lds
    v_mfma_f32_32x32x16_bf16 v[112:127], a[76:79], v[60:63], v[112:127]
    buffer_load_dwordx4 v14, s[8:11], s43 offen offset:1024 lds
    s_waitcnt vmcnt(20)
    ds_read_b64_tr_b16 v[56:57], v18 offset:22528
    ds_read_b64_tr_b16 v[58:59], v18 offset:23552
    ds_read_b64_tr_b16 v[60:61], v19 offset:22528
    ds_read_b64_tr_b16 v[62:63], v19 offset:23552
    s_waitcnt lgkmcnt(4)
    v_mfma_f32_32x32x16_bf16 v[64:79], a[80:83], v[40:43], v[64:79]
    v_mfma_f32_32x32x16_bf16 v[80:95], a[80:83], v[44:47], v[80:95]
    v_mfma_f32_32x32x16_bf16 v[96:111], a[84:87], v[40:43], v[96:111]
    s_add_u32 m0, s42, 12288
    s_add_u32 s43, s40, 393216
    buffer_load_dwordx4 v13, s[8:11], s43 offen lds
    v_mfma_f32_32x32x16_bf16 v[112:127], a[84:87], v[44:47], v[112:127]
    buffer_load_dwordx4 v14, s[8:11], s43 offen offset:1024 lds
    s_waitcnt vmcnt(18)
    ds_read_b64_tr_b16 v[40:41], v18 offset:24576
    ds_read_b64_tr_b16 v[42:43], v18 offset:25600
    ds_read_b64_tr_b16 v[44:45], v19 offset:24576
    ds_read_b64_tr_b16 v[46:47], v19 offset:25600
    s_waitcnt lgkmcnt(4)
    v_mfma_f32_32x32x16_bf16 v[64:79], a[88:91], v[56:59], v[64:79]
    v_mfma_f32_32x32x16_bf16 v[80:95], a[88:91], v[60:63], v[80:95]
    v_mfma_f32_32x32x16_bf16 v[96:111], a[92:95], v[56:59], v[96:111]
    s_add_u32 m0, s42, 14336
    s_add_u32 s43, s40, 458752
    buffer_load_dwordx4 v13, s[8:11], s43 offen lds
    v_mfma_f32_32x32x16_bf16 v[112:127], a[92:95], v[60:63], v[112:127]
    buffer_load_dwordx4 v14, s[8:11], s43 offen offset:1024 lds
    s_waitcnt vmcnt(16)
    ds_read_b64_tr_b16 v[56:57], v18 offset:26624
    ds_read_b64_tr_b16 v[58:59], v18 offset:27648
    ds_read_b64_tr_b16 v[60:61], v19 offset:26624
    ds_read_b64_tr_b16 v[62:63], v19 offset:27648
    s_waitcnt lgkmcnt(4)
    v_mfma_f32_32x32x16_bf16 v[64:79], a[96:99], v[40:43], v[64:79]
    v_mfma_f32_32x32x16_bf16 v[80:95], a[96:99], v[44:47], v[80:95]
    v_mfma_f32_32x32x16_bf16 v[96:111], a[100:103], v[40:43], v[96:111]
    v_mfma_f32_32x32x16_bf16 v[112:127], a[100:103], v[44:47], v[112:127]
    s_waitcnt vmcnt(12)
    ds_read_b64_tr_b16 v[40:41], v18 offset:28672
    ds_read_b64_tr_b16 v[42:43], v18 offset:29696
    ds_read_b64_tr_b16 v[44:45], v19 offset:28672
    ds_read_b64_tr_b16 v[46:47], v19 offset:29696
    s_waitcnt lgkmcnt(4)
    v_mfma_f32_32x32x16_bf16 v[64:79], a[104:107], v[56:59], v[64:79]
    v_mfma_f32_32x32x16_bf16 v[80:95], a[104:107], v[60:63], v[80:95]
    v_mfma_f32_32x32x16_bf16 v[96:111], a[108:111], v[56:59], v[96:111]
    v_mfma_f32_32x32x16_bf16 v[112:127], a[108:111], v[60:63], v[112:127]
    s_waitcnt vmcnt(8)
    ds_read_b64_tr_b16 v[56:57], v18 offset:30720
    ds_read_b64_tr_b16 v[58:59], v18 offset:31744
    ds_read_b64_tr_b16 v[60:61], v19 offset:30720
    ds_read_b64_tr_b16 v[62:63], v19 offset:31744
    s_waitcnt lgkmcnt(4)
    v_mfma_f32_32x32x16_bf16 v[64:79], a[112:115], v[40:43], v[64:79]
    v_mfma_f32_32x32x16_bf16 v[80:95], a[112:115], v[44:47], v[80:95]
    v_mfma_f32_32x32x16_bf16 v[96:111], a[116:119], v[40:43], v[96:111]
    v_mfma_f32_32x32x16_bf16 v[112:127], a[116:119], v[44:47], v[112:127]
    s_waitcnt lgkmcnt(0)
    v_mfma_f32_32x32x16_bf16 v[64:79], a[120:123], v[56:59], v[64:79]
    v_mfma_f32_32x32x16_bf16 v[80:95], a[120:123], v[60:63], v[80:95]
    v_mfma_f32_32x32x16_bf16 v[96:111], a[124:127], v[56:59], v[96:111]
    v_mfma_f32_32x32x16_bf16 v[112:127], a[124:127], v[60:63], v[112:127]
    v_add_u32 v20, s42, v5
    s_xor_b32 s26, s3, 1
    s_lshl_b32 s26, s26, 15
    v_add_u32 v21, s26, v5
    s_xor_b32 s26, s3, 2
    s_lshl_b32 s26, s26, 15
    v_add_u32 v22, s26, v5
    s_xor_b32 s26, s3, 3
    s_lshl_b32 s26, s26, 15
    v_add_u32 v23, s26, v5
    ds_write_b128 v20, v[80:83] offset:16384
    ds_write_b128 v20, v[84:87] offset:17408
    ds_write_b128 v20, v[88:91] offset:18432
    ds_write_b128 v20, v[92:95] offset:19456
    ds_write_b128 v20, v[96:99] offset:20480
    ds_write_b128 v20, v[100:103] offset:21504
    ds_write_b128 v20, v[104:107] offset:22528
    ds_write_b128 v20, v[108:111] offset:23552
    ds_write_b128 v20, v[112:115] offset:24576
    ds_write_b128 v20, v[116:119] offset:25600
    ds_write_b128 v20, v[120:123] offset:26624
    ds_write_b128 v20, v[124:127] offset:27648
    v_lshlrev_b32 v32, 16, v24
    v_and_b32 v33, 0xffff0000, v24
    v_lshlrev_b32 v34, 16, v25
    v_and_b32 v35, 0xffff0000, v25
    v_lshlrev_b32 v36, 16, v26
    v_and_b32 v37, 0xffff0000, v26
    v_lshlrev_b32 v38, 16, v27
    v_and_b32 v39, 0xffff0000, v27
    v_lshlrev_b32 v40, 16, v28
    v_and_b32 v41, 0xffff0000, v28
    v_lshlrev_b32 v42, 16, v29
    v_and_b32 v43, 0xffff0000, v29
    v_lshlrev_b32 v44, 16, v30
    v_and_b32 v45, 0xffff0000, v30
    v_lshlrev_b32 v46, 16, v31
    v_and_b32 v47, 0xffff0000, v31
    s_waitcnt lgkmcnt(0)
    s_mov_b64 exec, 1
    ds_add_u32 v8, v9 offset:16
    s_mov_b64 exec, -1
    v_pk_add_f32 v[64:65], v[64:65], v[32:33]
    v_pk_add_f32 v[66:67], v[66:67], v[34:35]
    v_pk_add_f32 v[68:69], v[68:69], v[36:37]
    v_pk_add_f32 v[70:71], v[70:71], v[38:39]
    v_pk_add_f32 v[72:73], v[72:73], v[40:41]
    v_pk_add_f32 v[74:75], v[74:75], v[42:43]
    v_pk_add_f32 v[76:77], v[76:77], v[44:45]
    v_pk_add_f32 v[78:79], v[78:79], v[46:47]
    v_lshlrev_b32 v15, 12, v2
    v_add_u32 v15, s36, v15
    s_mov_b32 s44, 524288
sp_60:
    ds_read_b32 v10, v8 offset:16
    s_waitcnt lgkmcnt(0)
    v_readfirstlane_b32 s45, v10
    s_sub_u32 s44, s44, 1
    s_cbranch_scc1 spe_61
    s_cmp_ge_u32 s45, 4
    s_cbranch_scc1 spe_61
    s_sleep 0
    s_branch sp_60
spe_61:
    ds_read_b128 v[80:83], v21 offset:16384
    ds_read_b128 v[84:87], v21 offset:17408
    ds_read_b128 v[88:91], v21 offset:18432
    ds_read_b128 v[92:95], v21 offset:19456
    ds_read_b128 v[96:99], v22 offset:20480
    ds_read_b128 v[100:103], v22 offset:21504
    ds_read_b128 v[104:107], v22 offset:22528
    ds_read_b128 v[108:111], v22 offset:23552
    ds_read_b128 v[112:115], v23 offset:24576
    ds_read_b128 v[116:119], v23 offset:25600
    ds_read_b128 v[120:123], v23 offset:26624
    ds_read_b128 v[124:127], v23 offset:27648
    s_waitcnt lgkmcnt(8)
    v_pk_add_f32 v[64:65], v[64:65], v[80:81]
    v_pk_add_f32 v[66:67], v[66:67], v[82:83]
    v_pk_add_f32 v[68:69], v[68:69], v[84:85]
    v_pk_add_f32 v[70:71], v[70:71], v[86:87]
    v_pk_add_f32 v[72:73], v[72:73], v[88:89]
    v_pk_add_f32 v[74:75], v[74:75], v[90:91]
    v_pk_add_f32 v[76:77], v[76:77], v[92:93]
    v_pk_add_f32 v[78:79], v[78:79], v[94:95]
    s_waitcnt lgkmcnt(4)
    v_pk_add_f32 v[64:65], v[64:65], v[96:97]
    v_pk_add_f32 v[66:67], v[66:67], v[98:99]
    v_pk_add_f32 v[68:69], v[68:69], v[100:101]
    v_pk_add_f32 v[70:71], v[70:71], v[102:103]
    v_pk_add_f32 v[72:73], v[72:73], v[104:105]
    v_pk_add_f32 v[74:75], v[74:75], v[106:107]
    v_pk_add_f32 v[76:77], v[76:77], v[108:109]
    v_pk_add_f32 v[78:79], v[78:79], v[110:111]
    s_waitcnt lgkmcnt(0)
    v_pk_add_f32 v[64:65], v[64:65], v[112:113]
    v_pk_add_f32 v[66:67], v[66:67], v[114:115]
    v_pk_add_f32 v[68:69], v[68:69], v[116:117]
    v_pk_add_f32 v[70:71], v[70:71], v[118:119]
    v_pk_add_f32 v[72:73], v[72:73], v[120:121]
    v_pk_add_f32 v[74:75], v[74:75], v[122:123]
    v_pk_add_f32 v[76:77], v[76:77], v[124:125]
    v_pk_add_f32 v[78:79], v[78:79], v[126:127]
    s_mov_b64 exec, 1
    ds_add_u32 v8, v9 offset:44
    s_mov_b64 exec, -1
    v_mov_b32 v20, 0xbdd2d3e8
    v_mul_f32 v48, v64, v64
    v_mul_f32 v49, v65, v65
    v_mul_f32 v50, v66, v66
    v_mul_f32 v51, v67, v67
    v_mul_f32 v52, v68, v68
    v_mul_f32 v53, v69, v69
    v_mul_f32 v54, v70, v70
    v_mul_f32 v55, v71, v71
    v_fmaak_f32 v48, v48, v20, 0xc0135761
    v_fmaak_f32 v49, v49, v20, 0xc0135761
    v_fmaak_f32 v50, v50, v20, 0xc0135761
    v_fmaak_f32 v51, v51, v20, 0xc0135761
    v_fmaak_f32 v52, v52, v20, 0xc0135761
    v_fmaak_f32 v53, v53, v20, 0xc0135761
    v_fmaak_f32 v54, v54, v20, 0xc0135761
    v_fmaak_f32 v55, v55, v20, 0xc0135761
    v_mul_f32 v48, v48, v64
    v_mul_f32 v49, v49, v65
    v_mul_f32 v50, v50, v66
    v_mul_f32 v51, v51, v67
    v_mul_f32 v52, v52, v68
    v_mul_f32 v53, v53, v69
    v_mul_f32 v54, v54, v70
    v_mul_f32 v55, v55, v71
    v_exp_f32 v48, v48
    v_exp_f32 v49, v49
    v_exp_f32 v50, v50
    v_exp_f32 v51, v51
    v_exp_f32 v52, v52
    v_exp_f32 v53, v53
    v_exp_f32 v54, v54
    v_exp_f32 v55, v55
    v_add_f32 v48, 1.0, v48
    v_add_f32 v49, 1.0, v49
    v_add_f32 v50, 1.0, v50
    v_add_f32 v51, 1.0, v51
    v_add_f32 v52, 1.0, v52
    v_add_f32 v53, 1.0, v53
    v_add_f32 v54, 1.0, v54
    v_add_f32 v55, 1.0, v55
    v_rcp_f32 v48, v48
    v_rcp_f32 v49, v49
    v_rcp_f32 v50, v50
    v_rcp_f32 v51, v51
    v_rcp_f32 v52, v52
    v_rcp_f32 v53, v53
    v_rcp_f32 v54, v54
    v_rcp_f32 v55, v55
    v_mul_f32 v64, v64, v48
    v_mul_f32 v65, v65, v49
    v_mul_f32 v66, v66, v50
    v_mul_f32 v67, v67, v51
    v_mul_f32 v68, v68, v52
    v_mul_f32 v69, v69, v53
    v_mul_f32 v70, v70, v54
    v_mul_f32 v71, v71, v55
    v_cvt_pk_bf16_f32 v24, v64, v65
    v_cvt_pk_bf16_f32 v25, v66, v67
    v_cvt_pk_bf16_f32 v26, v68, v69
    v_cvt_pk_bf16_f32 v27, v70, v71
    buffer_store_dwordx4 v[24:27], v5, s[12:15], s39 offen offset:0 sc1
    v_mul_f32 v56, v72, v72
    v_mul_f32 v57, v73, v73
    v_mul_f32 v58, v74, v74
    v_mul_f32 v59, v75, v75
    v_mul_f32 v60, v76, v76
    v_mul_f32 v61, v77, v77
    v_mul_f32 v62, v78, v78
    v_mul_f32 v63, v79, v79
    v_fmaak_f32 v56, v56, v20, 0xc0135761
    v_fmaak_f32 v57, v57, v20, 0xc0135761
    v_fmaak_f32 v58, v58, v20, 0xc0135761
    v_fmaak_f32 v59, v59, v20, 0xc0135761
    v_fmaak_f32 v60, v60, v20, 0xc0135761
    v_fmaak_f32 v61, v61, v20, 0xc0135761
    v_fmaak_f32 v62, v62, v20, 0xc0135761
    v_fmaak_f32 v63, v63, v20, 0xc0135761
    v_mul_f32 v56, v56, v72
    v_mul_f32 v57, v57, v73
    v_mul_f32 v58, v58, v74
    v_mul_f32 v59, v59, v75
    v_mul_f32 v60, v60, v76
    v_mul_f32 v61, v61, v77
    v_mul_f32 v62, v62, v78
    v_mul_f32 v63, v63, v79
    v_exp_f32 v56, v56
    v_exp_f32 v57, v57
    v_exp_f32 v58, v58
    v_exp_f32 v59, v59
    v_exp_f32 v60, v60
    v_exp_f32 v61, v61
    v_exp_f32 v62, v62
    v_exp_f32 v63, v63
    v_add_f32 v56, 1.0, v56
    v_add_f32 v57, 1.0, v57
    v_add_f32 v58, 1.0, v58
    v_add_f32 v59, 1.0, v59
    v_add_f32 v60, 1.0, v60
    v_add_f32 v61, 1.0, v61
    v_add_f32 v62, 1.0, v62
    v_add_f32 v63, 1.0, v63
    v_rcp_f32 v56, v56
    v_rcp_f32 v57, v57
    v_rcp_f32 v58, v58
    v_rcp_f32 v59, v59
    v_rcp_f32 v60, v60
    v_rcp_f32 v61, v61
    v_rcp_f32 v62, v62
    v_rcp_f32 v63, v63
    v_mul_f32 v72, v72, v56
    v_mul_f32 v73, v73, v57
    v_mul_f32 v74, v74, v58
    v_mul_f32 v75, v75, v59
    v_mul_f32 v76, v76, v60
    v_mul_f32 v77, v77, v61
    v_mul_f32 v78, v78, v62
    v_mul_f32 v79, v79, v63
    v_cvt_pk_bf16_f32 v28, v72, v73
    v_cvt_pk_bf16_f32 v29, v74, v75
    v_cvt_pk_bf16_f32 v30, v76, v77
    v_cvt_pk_bf16_f32 v31, v78, v79
    buffer_store_dwordx4 v[28:31], v5, s[12:15], s39 offen offset:2048 sc1
    s_waitcnt vmcnt(0)
    s_mov_b64 exec, 1
    ds_add_rtn_u32 v10, v8, v9 offset:20
    s_mov_b64 exec, -1
    s_waitcnt lgkmcnt(0)
    v_readfirstlane_b32 s45, v10
    s_nop 1
    s_cmp_lg_u32 s45, 3
    s_cbranch_scc1 pube_62
    s_setprio 3
    s_mov_b32 s44, 524288
sp_63:
    ds_read_b32 v10, v8 offset:40
    s_waitcnt lgkmcnt(0)
    v_readfirstlane_b32 s45, v10
    s_sub_u32 s44, s44, 1
    s_cbranch_scc1 spe_64
    s_cmp_ge_u32 s45, 1
    s_cbranch_scc1 spe_64
    s_sleep 1
    s_branch sp_63
spe_64:
    v_mov_b32 v10, s45
    s_mov_b32 s44, 10616832
    s_mov_b64 exec, 255
    buffer_store_dword v10, v15, s[12:15], s44 offen sc1
    s_mov_b64 exec, 1
    ds_write_b32 v8, v9 offset:56
    s_mov_b64 exec, -1
    s_setprio 0
pube_62:
    s_mov_b32 s44, 524288
sp_65:
    ds_read_b32 v10, v8 offset:56
    s_waitcnt lgkmcnt(0)
    v_readfirstlane_b32 s45, v10
    s_sub_u32 s44, s44, 1
    s_cbranch_scc1 spe_66
    s_cmp_ge_u32 s45, 1
    s_cbranch_scc1 spe_66
    s_sleep 1
    s_branch sp_65
spe_66:
    s_setprio 2
    s_add_u32 m0, s42, 28672
    s_add_u32 s43, s40, 917504
    buffer_load_dwordx4 v13, s[8:11], s43 offen lds
    buffer_load_dwordx4 v14, s[8:11], s43 offen offset:1024 lds
    s_add_u32 m0, s42, 30720
    s_add_u32 s43, s40, 983040
    buffer_load_dwordx4 v13, s[8:11], s43 offen lds
    buffer_load_dwordx4 v14, s[8:11], s43 offen offset:1024 lds
    s_branch g_p3b
g_spare:
    s_mov_b64 exec, 1
    ds_add_u32 v8, v9 offset:44
    s_mov_b64 exec, -1
    v_lshrrev_b32 v6, 2, v2
    v_and_b32 v7, 3, v2
    v_lshlrev_b32 v6, 12, v6
    v_lshl_add_u32 v6, v7, 7, v6
    s_sub_u32 s36, s23, 28
    s_mul_i32 s36, s36, 448
    s_lshl_b32 s37, s3, 4
    s_add_u32 s36, s36, s37
    s_lshl_b32 s36, s36, 12
    s_lshl_b32 s37, s22, 9
    s_add_u32 s36, s36, s37
    s_mov_b32 s8, s60
    s_and_b32 s9, s61, 0xffff
    s_mov_b32 s10, 7340032
    s_mov_b32 s11, 0x20000
    s_waitcnt vmcnt(2)
    buffer_load_dword v32, v6, s[8:11], s36 offen
    s_add_u32 s36, s36, 262144
    s_waitcnt vmcnt(2)
    buffer_load_dword v33, v6, s[8:11], s36 offen
    s_add_u32 s36, s36, 262144
    s_waitcnt vmcnt(2)
    s_cmp_eq_u32 s2, 255
    s_cbranch_scc1 g_pfend
    s_mov_b32 s44, 524288
sp_67:
    ds_read_b32 v10, v8 offset:60
    s_waitcnt lgkmcnt(0)
    v_readfirstlane_b32 s45, v10
    s_sub_u32 s44, s44, 1
    s_cbranch_scc1 spe_68
    s_cmp_ge_u32 s45, 4
    s_cbranch_scc1 spe_68
    s_sleep 4
    s_branch sp_67
spe_68:
    buffer_load_dword v34, v6, s[8:11], s36 offen
    s_add_u32 s36, s36, 262144
    s_waitcnt vmcnt(2)
    buffer_load_dword v35, v6, s[8:11], s36 offen
    s_add_u32 s36, s36, 262144
    s_waitcnt vmcnt(2)
    s_mov_b32 s44, 524288
sp_69:
    ds_read_b32 v10, v8 offset:64
    s_waitcnt lgkmcnt(0)
    v_readfirstlane_b32 s45, v10
    s_sub_u32 s44, s44, 1
    s_cbranch_scc1 spe_70
    s_cmp_ge_u32 s45, 4
    s_cbranch_scc1 spe_70
    s_sleep 4
    s_branch sp_69
spe_70:
    buffer_load_dword v36, v6, s[8:11], s36 offen
    s_add_u32 s36, s36, 262144
    s_waitcnt vmcnt(2)
    buffer_load_dword v37, v6, s[8:11], s36 offen
    s_add_u32 s36, s36, 262144
    s_waitcnt vmcnt(2)
    buffer_load_dword v38, v6, s[8:11], s36 offen
    s_add_u32 s36, s36, 262144
g_pfend:
g_p3:
    s_lshl_b32 s24, s22, 2
    s_and_b32 s25, s23, 3
    s_add_u32 s24, s24, s25
    s_lshr_b32 s25, s23, 2
    v_lshrrev_b32 v3, 3, v2
    v_bfe_u32 v4, v2, 4, 1
    v_lshlrev_b32 v4, 2, v4
    v_xor_b32 v4, v4, v2
    v_and_b32 v4, 7, v4
    v_lshlrev_b32 v4, 4, v4
    v_lshl_add_u32 v13, v3, 12, v4
    s_lshl_b32 s27, s24, 7
    v_add_u32 v13, s27, v13
    v_add_u32 v14, 31744, v13
    s_mul_i32 s40, s3, 1835008
    s_mul_i32 s33, s25, 229376
    s_mul_i32 s27, s3, 57344
    s_add_u32 s33, s33, s27
    s_add_u32 s33, s33, 11534336
    s_lshl_b32 s27, s34, 10
    v_xor_b32 v6, s27, v5
    v_xor_b32 v7, 0x400, v6
    s_mov_b32 s8, s60
    s_and_b32 s9, s61, 0xffff
    s_mov_b32 s10, 7340032
    s_mov_b32 s11, 0x20000
    s_add_u32 m0, s42, 0
    s_add_u32 s43, s40, 0
    buffer_load_dwordx4 v13, s[8:11], s43 offen lds
    buffer_load_dwordx4 v14, s[8:11], s43 offen offset:1024 lds
    s_add_u32 m0, s42, 2048
    s_add_u32 s43, s40, 65536
    buffer_load_dwordx4 v13, s[8:11], s43 offen lds
    buffer_load_dwordx4 v14, s[8:11], s43 offen offset:1024 lds
    s_add_u32 m0, s42, 4096
    s_add_u32 s43, s40, 131072
    buffer_load_dwordx4 v13, s[8:11], s43 offen lds
    buffer_load_dwordx4 v14, s[8:11], s43 offen offset:1024 lds
    s_add_u32 m0, s42, 6144
    s_add_u32 s43, s40, 196608
    buffer_load_dwordx4 v13, s[8:11], s43 offen lds
    buffer_load_dwordx4 v14, s[8:11], s43 offen offset:1024 lds
    s_add_u32 m0, s42, 8192
    s_add_u32 s43, s40, 262144
    buffer_load_dwordx4 v13, s[8:11], s43 offen lds
    buffer_load_dwordx4 v14, s[8:11], s43 offen offset:1024 lds
    s_add_u32 m0, s42, 10240
    s_add_u32 s43, s40, 327680
    buffer_load_dwordx4 v13, s[8:11], s43 offen lds
    buffer_load_dwordx4 v14, s[8:11], s43 offen offset:1024 lds
    s_add_u32 m0, s42, 12288
    s_add_u32 s43, s40, 393216
    buffer_load_dwordx4 v13, s[8:11], s43 offen lds
    buffer_load_dwordx4 v14, s[8:11], s43 offen offset:1024 lds
    s_add_u32 m0, s42, 14336
    s_add_u32 s43, s40, 458752
    buffer_load_dwordx4 v13, s[8:11], s43 offen lds
    buffer_load_dwordx4 v14, s[8:11], s43 offen offset:1024 lds
    s_add_u32 m0, s42, 28672
    s_add_u32 s43, s40, 917504
    buffer_load_dwordx4 v13, s[8:11], s43 offen lds
    buffer_load_dwordx4 v14, s[8:11], s43 offen offset:1024 lds
    s_add_u32 m0, s42, 30720
    s_add_u32 s43, s40, 983040
    buffer_load_dwordx4 v13, s[8:11], s43 offen lds
    buffer_load_dwordx4 v14, s[8:11], s43 offen offset:1024 lds
g_p3b:
    s_mov_b32 s44, 524288
sp_71:
    ds_read_b32 v10, v8 offset:44
    s_waitcnt lgkmcnt(0)
    v_readfirstlane_b32 s45, v10
    s_sub_u32 s44, s44, 1
    s_cbranch_scc1 spe_72
    s_cmp_ge_u32 s45, 4
    s_cbranch_scc1 spe_72
    s_sleep 0
    s_branch sp_71
spe_72:
    s_add_u32 m0, s42, 16384
    s_add_u32 s43, s40, 524288
    buffer_load_dwordx4 v13, s[8:11], s43 offen lds
    buffer_load_dwordx4 v14, s[8:11], s43 offen offset:1024 lds
    s_add_u32 m0, s42, 18432
    s_add_u32 s43, s40, 589824
    buffer_load_dwordx4 v13, s[8:11], s43 offen lds
    buffer_load_dwordx4 v14, s[8:11], s43 offen offset:1024 lds
    s_add_u32 m0, s42, 20480
    s_add_u32 s43, s40, 655360
    buffer_load_dwordx4 v13, s[8:11], s43 offen lds
    buffer_load_dwordx4 v14, s[8:11], s43 offen offset:1024 lds
    s_add_u32 m0, s42, 22528
    s_add_u32 s43, s40, 720896
    buffer_load_dwordx4 v13, s[8:11], s43 offen lds
    buffer_load_dwordx4 v14, s[8:11], s43 offen offset:1024 lds
    s_add_u32 m0, s42, 24576
    s_add_u32 s43, s40, 786432
    buffer_load_dwordx4 v13, s[8:11], s43 offen lds
    buffer_load_dwordx4 v14, s[8:11], s43 offen offset:1024 lds
    s_add_u32 m0, s42, 26624
    s_add_u32 s43, s40, 851968
    buffer_load_dwordx4 v13, s[8:11], s43 offen lds
    buffer_load_dwordx4 v14, s[8:11], s43 offen offset:1024 lds
    s_mov_b32 s16, s62
    s_and_b32 s17, s63, 0xffff
    s_mov_b32 s18, 4096
    s_mov_b32 s19, 0x20000
    s_mov_b32 s28, s66
    s_and_b32 s29, s67, 0xffff
    s_mov_b32 s30, 2097152
    s_mov_b32 s31, 0x20000
    v_and_b32 v3, 31, v2
    v_lshrrev_b32 v4, 5, v2
    s_lshl_b32 s26, s24, 6
    s_lshl_b32 s27, s35, 5
    s_add_u32 s26, s26, s27
    v_add_u32 v3, s26, v3
    v_lshlrev_b32 v20, 1, v3
    buffer_load_ushort v24, v20, s[16:19], 0 offen
    v_lshlrev_b32 v21, 2, v3
    v_lshlrev_b32 v3, 10, v3
    v_lshl_add_u32 v3, v4, 4, v3
    s_lshl_b32 s38, s25, 7
    s_lshl_b32 s39, s34, 6
    s_add_u32 s38, s38, s39
    s_mov_b64 exec, 1
    ds_add_u32 v8, v9 offset:80
    s_mov_b64 exec, -1
    s_mov_b32 s44, 524288
sp_73:
    ds_read_b32 v10, v8 offset:24
    s_waitcnt lgkmcnt(0)
    v_readfirstlane_b32 s45, v10
    s_sub_u32 s44, s44, 1
    s_cbranch_scc1 spe_74
    s_cmp_ge_u32 s45, 1
    s_cbranch_scc1 spe_74
    s_sleep 1
    s_branch sp_73
spe_74:
    s_mov_b32 s39, 10502144
    buffer_load_dword v26, v21, s[12:15], s39 offen sc1
    s_add_u32 s43, s33, 0
    buffer_load_dwordx4 a[0:3], v6, s[12:15], s43 offen sc1
    buffer_load_dwordx4 a[4:7], v7, s[12:15], s43 offen sc1
    s_add_u32 s43, s33, 2048
    buffer_load_dwordx4 a[8:11], v6, s[12:15], s43 offen sc1
    buffer_load_dwordx4 a[12:15], v7, s[12:15], s43 offen sc1
    s_add_u32 s43, s33, 4096
    buffer_load_dwordx4 a[16:19], v6, s[12:15], s43 offen sc1
    buffer_load_dwordx4 a[20:23], v7, s[12:15], s43 offen sc1
    s_add_u32 s43, s33, 6144
    buffer_load_dwordx4 a[24:27], v6, s[12:15], s43 offen sc1
    buffer_load_dwordx4 a[28:31], v7, s[12:15], s43 offen sc1
    s_add_u32 s43, s33, 8192
    buffer_load_dwordx4 a[32:35], v6, s[12:15], s43 offen sc1
    buffer_load_dwordx4 a[36:39], v7, s[12:15], s43 offen sc1
    s_add_u32 s43, s33, 10240
    buffer_load_dwordx4 a[40:43], v6, s[12:15], s43 offen sc1
    buffer_load_dwordx4 a[44:47], v7, s[12:15], s43 offen sc1
    s_add_u32 s43, s33, 12288
    buffer_load_dwordx4 a[48:51], v6, s[12:15], s43 offen sc1
    buffer_load_dwordx4 a[52:55], v7, s[12:15], s43 offen sc1
    s_add_u32 s43, s33, 14336
    buffer_load_dwordx4 a[56:59], v6, s[12:15], s43 offen sc1
    buffer_load_dwordx4 a[60:63], v7, s[12:15], s43 offen sc1
    s_add_u32 s43, s33, 16384
    buffer_load_dwordx4 a[64:67], v6, s[12:15], s43 offen sc1
    buffer_load_dwordx4 a[68:71], v7, s[12:15], s43 offen sc1
    s_waitcnt vmcnt(50)
    ds_read_b64_tr_b16 v[32:33], v18 offset:0
    ds_read_b64_tr_b16 v[34:35], v18 offset:1024
    ds_read_b64_tr_b16 v[36:37], v19 offset:0
    ds_read_b64_tr_b16 v[38:39], v19 offset:1024
    s_waitcnt vmcnt(48)
    ds_read_b64_tr_b16 v[40:41], v18 offset:2048
    ds_read_b64_tr_b16 v[42:43], v18 offset:3072
    ds_read_b64_tr_b16 v[44:45], v19 offset:2048
    ds_read_b64_tr_b16 v[46:47], v19 offset:3072
    s_waitcnt vmcnt(16) lgkmcnt(4)
    v_mfma_f32_32x32x16_bf16 v[64:79], a[0:3], v[32:35], 0
    s_add_u32 s43, s33, 18432
    buffer_load_dwordx4 a[72:75], v6, s[12:15], s43 offen sc1
    v_mfma_f32_32x32x16_bf16 v[80:95], a[0:3], v[36:39], 0
    buffer_load_dwordx4 a[76:79], v7, s[12:15], s43 offen sc1
    v_mfma_f32_32x32x16_bf16 v[96:111], a[4:7], v[32:35], 0
    v_mfma_f32_32x32x16_bf16 v[112:127], a[4:7], v[36:39], 0
    ds_read_b64_tr_b16 v[32:33], v18 offset:4096
    ds_read_b64_tr_b16 v[34:35], v18 offset:5120
    ds_read_b64_tr_b16 v[36:37], v19 offset:4096
    ds_read_b64_tr_b16 v[38:39], v19 offset:5120
    s_waitcnt vmcnt(16) lgkmcnt(4)
    v_mfma_f32_32x32x16_bf16 v[64:79], a[8:11], v[40:43], v[64:79]
    s_add_u32 s43, s33, 20480
    buffer_load_dwordx4 a[0:3], v6, s[12:15], s43 offen sc1
    v_mfma_f32_32x32x16_bf16 v[80:95], a[8:11], v[44:47], v[80:95]
    buffer_load_dwordx4 a[4:7], v7, s[12:15], s43 offen sc1
    v_mfma_f32_32x32x16_bf16 v[96:111], a[12:15], v[40:43], v[96:111]
    s_add_u32 m0, s42, 0
    s_add_u32 s43, s40, 1048576
    buffer_load_dwordx4 v13, s[8:11], s43 offen lds
    v_mfma_f32_32x32x16_bf16 v[112:127], a[12:15], v[44:47], v[112:127]
    buffer_load_dwordx4 v14, s[8:11], s43 offen offset:1024 lds
    ds_read_b64_tr_b16 v[40:41], v18 offset:6144
    ds_read_b64_tr_b16 v[42:43], v18 offset:7168
    ds_read_b64_tr_b16 v[44:45], v19 offset:6144
    ds_read_b64_tr_b16 v[46:47], v19 offset:7168
    s_waitcnt vmcnt(18) lgkmcnt(4)
    v_mfma_f32_32x32x16_bf16 v[64:79], a[16:19], v[32:35], v[64:79]
    s_add_u32 s43, s33, 22528
    buffer_load_dwordx4 a[8:11], v6, s[12:15], s43 offen sc1
    v_mfma_f32_32x32x16_bf16 v[80:95], a[16:19], v[36:39], v[80:95]
    buffer_load_dwordx4 a[12:15], v7, s[12:15], s43 offen sc1
    v_mfma_f32_32x32x16_bf16 v[96:111], a[20:23], v[32:35], v[96:111]
    s_add_u32 m0, s42, 2048
    s_add_u32 s43, s40, 1114112
    buffer_load_dwordx4 v13, s[8:11], s43 offen lds
    v_mfma_f32_32x32x16_bf16 v[112:127], a[20:23], v[36:39], v[112:127]
    buffer_load_dwordx4 v14, s[8:11], s43 offen offset:1024 lds
    ds_read_b64_tr_b16 v[32:33], v18 offset:8192
    ds_read_b64_tr_b16 v[34:35], v18 offset:9216
    ds_read_b64_tr_b16 v[36:37], v19 offset:8192
    ds_read_b64_tr_b16 v[38:39], v19 offset:9216
    s_waitcnt vmcnt(20) lgkmcnt(4)
    v_mfma_f32_32x32x16_bf16 v[64:79], a[24:27], v[40:43], v[64:79]
    s_add_u32 s43, s33, 24576
    buffer_load_dwordx4 a[16:19], v6, s[12:15], s43 offen sc1
    v_mfma_f32_32x32x16_bf16 v[80:95], a[24:27], v[44:47], v[80:95]
    buffer_load_dwordx4 a[20:23], v7, s[12:15], s43 offen sc1
    v_mfma_f32_32x32x16_bf16 v[96:111], a[28:31], v[40:43], v[96:111]
    v_mfma_f32_32x32x16_bf16 v[112:127], a[28:31], v[44:47], v[112:127]
    ds_read_b64_tr_b16 v[40:41], v18 offset:10240
    ds_read_b64_tr_b16 v[42:43], v18 offset:11264
    ds_read_b64_tr_b16 v[44:45], v19 offset:10240
    ds_read_b64_tr_b16 v[46:47], v19 offset:11264
    s_waitcnt vmcnt(20) lgkmcnt(4)
    v_mfma_f32_32x32x16_bf16 v[64:79], a[32:35], v[32:35], v[64:79]
    s_add_u32 s43, s33, 26624
    buffer_load_dwordx4 a[24:27], v6, s[12:15], s43 offen sc1
    v_mfma_f32_32x32x16_bf16 v[80:95], a[32:35], v[36:39], v[80:95]
    buffer_load_dwordx4 a[28:31], v7, s[12:15], s43 offen sc1
    v_mfma_f32_32x32x16_bf16 v[96:111], a[36:39], v[32:35], v[96:111]
    s_add_u32 m0, s42, 4096
    s_add_u32 s43, s40, 1179648
    buffer_load_dwordx4 v13, s[8:11], s43 offen lds
    v_mfma_f32_32x32x16_bf16 v[112:127], a[36:39], v[36:39], v[112:127]
    buffer_load_dwordx4 v14, s[8:11], s43 offen offset:1024 lds
    ds_read_b64_tr_b16 v[32:33], v18 offset:12288
    ds_read_b64_tr_b16 v[34:35], v18 offset:13312
    ds_read_b64_tr_b16 v[36:37], v19 offset:12288
    ds_read_b64_tr_b16 v[38:39], v19 offset:13312
    s_waitcnt vmcnt(22) lgkmcnt(4)
    v_mfma_f32_32x32x16_bf16 v[64:79], a[40:43], v[40:43], v[64:79]
    s_add_u32 s43, s33, 28672
    buffer_load_dwordx4 a[32:35], v6, s[12:15], s43 offen sc1
    v_mfma_f32_32x32x16_bf16 v[80:95], a[40:43], v[44:47], v[80:95]
    buffer_load_dwordx4 a[36:39], v7, s[12:15], s43 offen sc1
    v_mfma_f32_32x32x16_bf16 v[96:111], a[44:47], v[40:43], v[96:111]
    v_mfma_f32_32x32x16_bf16 v[112:127], a[44:47], v[44:47], v[112:127]
    ds_read_b64_tr_b16 v[40:41], v18 offset:14336
    ds_read_b64_tr_b16 v[42:43], v18 offset:15360
    ds_read_b64_tr_b16 v[44:45], v19 offset:14336
    ds_read_b64_tr_b16 v[46:47], v19 offset:15360
    s_waitcnt vmcnt(22) lgkmcnt(4)
    v_mfma_f32_32x32x16_bf16 v[64:79], a[48:51], v[32:35], v[64:79]
    s_add_u32 s43, s33, 30720
    buffer_load_dwordx4 a[40:43], v6, s[12:15], s43 offen sc1
    v_mfma_f32_32x32x16_bf16 v[80:95], a[48:51], v[36:39], v[80:95]
    buffer_load_dwordx4 a[44:47], v7, s[12:15], s43 offen sc1
    v_mfma_f32_32x32x16_bf16 v[96:111], a[52:55], v[32:35], v[96:111]
    s_add_u32 m0, s42, 6144
    s_add_u32 s43, s40, 1245184
    buffer_load_dwordx4 v13, s[8:11], s43 offen lds
    v_mfma_f32_32x32x16_bf16 v[112:127], a[52:55], v[36:39], v[112:127]
    buffer_load_dwordx4 v14, s[8:11], s43 offen offset:1024 lds
    ds_read_b64_tr_b16 v[32:33], v18 offset:16384
    ds_read_b64_tr_b16 v[34:35], v18 offset:17408
    ds_read_b64_tr_b16 v[36:37], v19 offset:16384
    ds_read_b64_tr_b16 v[38:39], v19 offset:17408
    s_waitcnt vmcnt(24) lgkmcnt(4)
    v_mfma_f32_32x32x16_bf16 v[64:79], a[56:59], v[40:43], v[64:79]
    s_add_u32 s43, s33, 32768
    buffer_load_dwordx4 a[48:51], v6, s[12:15], s43 offen sc1
    v_mfma_f32_32x32x16_bf16 v[80:95], a[56:59], v[44:47], v[80:95]
    buffer_load_dwordx4 a[52:55], v7, s[12:15], s43 offen sc1
    v_mfma_f32_32x32x16_bf16 v[96:111], a[60:63], v[40:43], v[96:111]
    v_mfma_f32_32x32x16_bf16 v[112:127], a[60:63], v[44:47], v[112:127]
    ds_read_b64_tr_b16 v[40:41], v18 offset:18432
    ds_read_b64_tr_b16 v[42:43], v18 offset:19456
    ds_read_b64_tr_b16 v[44:45], v19 offset:18432
    ds_read_b64_tr_b16 v[46:47], v19 offset:19456
    s_waitcnt vmcnt(24) lgkmcnt(4)
    v_mfma_f32_32x32x16_bf16 v[64:79], a[64:67], v[32:35], v[64:79]
    s_add_u32 s43, s33, 34816
    buffer_load_dwordx4 a[56:59], v6, s[12:15], s43 offen sc1
    v_mfma_f32_32x32x16_bf16 v[80:95], a[64:67], v[36:39], v[80:95]
    buffer_load_dwordx4 a[60:63], v7, s[12:15], s43 offen sc1
    v_mfma_f32_32x32x16_bf16 v[96:111], a[68:71], v[32:35], v[96:111]
    s_add_u32 m0, s42, 8192
    s_add_u32 s43, s40, 1310720
    buffer_load_dwordx4 v13, s[8:11], s43 offen lds
    v_mfma_f32_32x32x16_bf16 v[112:127], a[68:71], v[36:39], v[112:127]
    buffer_load_dwordx4 v14, s[8:11], s43 offen offset:1024 lds
    ds_read_b64_tr_b16 v[32:33], v18 offset:20480
    ds_read_b64_tr_b16 v[34:35], v18 offset:21504
    ds_read_b64_tr_b16 v[36:37], v19 offset:20480
    ds_read_b64_tr_b16 v[38:39], v19 offset:21504
    s_waitcnt vmcnt(26) lgkmcnt(4)
    v_mfma_f32_32x32x16_bf16 v[64:79], a[72:75], v[40:43], v[64:79]
    s_add_u32 s43, s33, 36864
    buffer_load_dwordx4 a[64:67], v6, s[12:15], s43 offen sc1
    v_mfma_f32_32x32x16_bf16 v[80:95], a[72:75], v[44:47], v[80:95]
    buffer_load_dwordx4 a[68:71], v7, s[12:15], s43 offen sc1
    v_mfma_f32_32x32x16_bf16 v[96:111], a[76:79], v[40:43], v[96:111]
    s_add_u32 m0, s42, 10240
    s_add_u32 s43, s40, 1376256
    buffer_load_dwordx4 v13, s[8:11], s43 offen lds
    v_mfma_f32_32x32x16_bf16 v[112:127], a[76:79], v[44:47], v[112:127]
    buffer_load_dwordx4 v14, s[8:11], s43 offen offset:1024 lds
    ds_read_b64_tr_b16 v[40:41], v18 offset:22528
    ds_read_b64_tr_b16 v[42:43], v18 offset:23552
    ds_read_b64_tr_b16 v[44:45], v19 offset:22528
    ds_read_b64_tr_b16 v[46:47], v19 offset:23552
    s_waitcnt vmcnt(28) lgkmcnt(4)
    v_mfma_f32_32x32x16_bf16 v[64:79], a[0:3], v[32:35], v[64:79]
    s_add_u32 s43, s33, 38912
    buffer_load_dwordx4 a[72:75], v6, s[12:15], s43 offen sc1
    v_mfma_f32_32x32x16_bf16 v[80:95], a[0:3], v[36:39], v[80:95]
    buffer_load_dwordx4 a[76:79], v7, s[12:15], s43 offen sc1
    v_mfma_f32_32x32x16_bf16 v[96:111], a[4:7], v[32:35], v[96:111]
    v_mfma_f32_32x32x16_bf16 v[112:127], a[4:7], v[36:39], v[112:127]
    ds_read_b64_tr_b16 v[32:33], v18 offset:24576
    ds_read_b64_tr_b16 v[34:35], v18 offset:25600
    ds_read_b64_tr_b16 v[36:37], v19 offset:24576
    ds_read_b64_tr_b16 v[38:39], v19 offset:25600
    s_waitcnt vmcnt(26) lgkmcnt(4)
    v_mfma_f32_32x32x16_bf16 v[64:79], a[8:11], v[40:43], v[64:79]
    s_add_u32 s43, s33, 40960
    buffer_load_dwordx4 a[0:3], v6, s[12:15], s43 offen sc1
    v_mfma_f32_32x32x16_bf16 v[80:95], a[8:11], v[44:47], v[80:95]
    buffer_load_dwordx4 a[4:7], v7, s[12:15], s43 offen sc1
    v_mfma_f32_32x32x16_bf16 v[96:111], a[12:15], v[40:43], v[96:111]
    s_add_u32 m0, s42, 12288
    s_add_u32 s43, s40, 1441792
    buffer_load_dwordx4 v13, s[8:11], s43 offen lds
    v_mfma_f32_32x32x16_bf16 v[112:127], a[12:15], v[44:47], v[112:127]
    buffer_load_dwordx4 v14, s[8:11], s43 offen offset:1024 lds
    ds_read_b64_tr_b16 v[40:41], v18 offset:26624
    ds_read_b64_tr_b16 v[42:43], v18 offset:27648
    ds_read_b64_tr_b16 v[44:45], v19 offset:26624
    ds_read_b64_tr_b16 v[46:47], v19 offset:27648
    s_waitcnt vmcnt(26) lgkmcnt(4)
    v_mfma_f32_32x32x16_bf16 v[64:79], a[16:19], v[32:35], v[64:79]
    s_add_u32 s43, s33, 43008
    buffer_load_dwordx4 a[8:11], v6, s[12:15], s43 offen sc1
    v_mfma_f32_32x32x16_bf16 v[80:95], a[16:19], v[36:39], v[80:95]
    buffer_load_dwordx4 a[12:15], v7, s[12:15], s43 offen sc1
    v_mfma_f32_32x32x16_bf16 v[96:111], a[20:23], v[32:35], v[96:111]
    v_mfma_f32_32x32x16_bf16 v[112:127], a[20:23], v[36:39], v[112:127]
    ds_read_b64_tr_b16 v[32:33], v18 offset:28672
    ds_read_b64_tr_b16 v[34:35], v18 offset:29696
    ds_read_b64_tr_b16 v[36:37], v19 offset:28672
    ds_read_b64_tr_b16 v[38:39], v19 offset:29696
    s_waitcnt vmcnt(26) lgkmcnt(4)
    v_mfma_f32_32x32x16_bf16 v[64:79], a[24:27], v[40:43], v[64:79]
    s_add_u32 s43, s33, 45056
    buffer_load_dwordx4 a[16:19], v6, s[12:15], s43 offen sc1
    v_mfma_f32_32x32x16_bf16 v[80:95], a[24:27], v[44:47], v[80:95]
    buffer_load_dwordx4 a[20:23], v7, s[12:15], s43 offen sc1
    v_mfma_f32_32x32x16_bf16 v[96:111], a[28:31], v[40:43], v[96:111]
    s_add_u32 m0, s42, 14336
    s_add_u32 s43, s40, 1507328
    buffer_load_dwordx4 v13, s[8:11], s43 offen lds
    v_mfma_f32_32x32x16_bf16 v[112:127], a[28:31], v[44:47], v[112:127]
    buffer_load_dwordx4 v14, s[8:11], s43 offen offset:1024 lds
    ds_read_b64_tr_b16 v[40:41], v18 offset:30720
    ds_read_b64_tr_b16 v[42:43], v18 offset:31744
    ds_read_b64_tr_b16 v[44:45], v19 offset:30720
    ds_read_b64_tr_b16 v[46:47], v19 offset:31744
    s_waitcnt vmcnt(26) lgkmcnt(4)
    v_mfma_f32_32x32x16_bf16 v[64:79], a[32:35], v[32:35], v[64:79]
    s_add_u32 s43, s33, 47104
    buffer_load_dwordx4 a[24:27], v6, s[12:15], s43 offen sc1
    v_mfma_f32_32x32x16_bf16 v[80:95], a[32:35], v[36:39], v[80:95]
    buffer_load_dwordx4 a[28:31], v7, s[12:15], s43 offen sc1
    v_mfma_f32_32x32x16_bf16 v[96:111], a[36:39], v[32:35], v[96:111]
    v_mfma_f32_32x32x16_bf16 v[112:127], a[36:39], v[36:39], v[112:127]
    ds_read_b64_tr_b16 v[32:33], v18 offset:0
    ds_read_b64_tr_b16 v[34:35], v18 offset:1024
    ds_read_b64_tr_b16 v[36:37], v19 offset:0
    ds_read_b64_tr_b16 v[38:39], v19 offset:1024
    s_waitcnt vmcnt(26) lgkmcnt(4)
    v_mfma_f32_32x32x16_bf16 v[64:79], a[40:43], v[40:43], v[64:79]
    s_add_u32 s43, s33, 49152
    buffer_load_dwordx4 a[32:35], v6, s[12:15], s43 offen sc1
    v_mfma_f32_32x32x16_bf16 v[80:95], a[40:43], v[44:47], v[80:95]
    buffer_load_dwordx4 a[36:39], v7, s[12:15], s43 offen sc1
    v_mfma_f32_32x32x16_bf16 v[96:111], a[44:47], v[40:43], v[96:111]
    s_add_u32 m0, s42, 16384
    s_add_u32 s43, s40, 1572864
    buffer_load_dwordx4 v13, s[8:11], s43 offen lds
    v_mfma_f32_32x32x16_bf16 v[112:127], a[44:47], v[44:47], v[112:127]
    buffer_load_dwordx4 v14, s[8:11], s43 offen offset:1024 lds
    ds_read_b64_tr_b16 v[40:41], v18 offset:2048
    ds_read_b64_tr_b16 v[42:43], v18 offset:3072
    ds_read_b64_tr_b16 v[44:45], v19 offset:2048
    ds_read_b64_tr_b16 v[46:47], v19 offset:3072
    s_waitcnt vmcnt(26) lgkmcnt(4)
    v_mfma_f32_32x32x16_bf16 v[64:79], a[48:51], v[32:35], v[64:79]
    s_add_u32 s43, s33, 51200
    buffer_load_dwordx4 a[40:43], v6, s[12:15], s43 offen sc1
    v_mfma_f32_32x32x16_bf16 v[80:95], a[48:51], v[36:39], v[80:95]
    buffer_load_dwordx4 a[44:47], v7, s[12:15], s43 offen sc1
    v_mfma_f32_32x32x16_bf16 v[96:111], a[52:55], v[32:35], v[96:111]
    s_add_u32 m0, s42, 18432
    s_add_u32 s43, s40, 1638400
    buffer_load_dwordx4 v13, s[8:11], s43 offen lds
    v_mfma_f32_32x32x16_bf16 v[112:127], a[52:55], v[36:39], v[112:127]
    buffer_load_dwordx4 v14, s[8:11], s43 offen offset:1024 lds
    ds_read_b64_tr_b16 v[32:33], v18 offset:4096
    ds_read_b64_tr_b16 v[34:35], v18 offset:5120
    ds_read_b64_tr_b16 v[36:37], v19 offset:4096
    ds_read_b64_tr_b16 v[38:39], v19 offset:5120
    s_waitcnt vmcnt(28) lgkmcnt(4)
    v_mfma_f32_32x32x16_bf16 v[64:79], a[56:59], v[40:43], v[64:79]
    s_add_u32 s43, s33, 53248
    buffer_load_dwordx4 a[48:51], v6, s[12:15], s43 offen sc1
    v_mfma_f32_32x32x16_bf16 v[80:95], a[56:59], v[44:47], v[80:95]
    buffer_load_dwordx4 a[52:55], v7, s[12:15], s43 offen sc1
    v_mfma_f32_32x32x16_bf16 v[96:111], a[60:63], v[40:43], v[96:111]
    v_mfma_f32_32x32x16_bf16 v[112:127], a[60:63], v[44:47], v[112:127]
    ds_read_b64_tr_b16 v[40:41], v18 offset:6144
    ds_read_b64_tr_b16 v[42:43], v18 offset:7168
    ds_read_b64_tr_b16 v[44:45], v19 offset:6144
    ds_read_b64_tr_b16 v[46:47], v19 offset:7168
    s_waitcnt vmcnt(26) lgkmcnt(4)
    v_mfma_f32_32x32x16_bf16 v[64:79], a[64:67], v[32:35], v[64:79]
    s_add_u32 s43, s33, 55296
    buffer_load_dwordx4 a[56:59], v6, s[12:15], s43 offen sc1
    v_mfma_f32_32x32x16_bf16 v[80:95], a[64:67], v[36:39], v[80:95]
    buffer_load_dwordx4 a[60:63], v7, s[12:15], s43 offen sc1
    v_mfma_f32_32x32x16_bf16 v[96:111], a[68:71], v[32:35], v[96:111]
    s_add_u32 m0, s42, 20480
    s_add_u32 s43, s40, 1703936
    buffer_load_dwordx4 v13, s[8:11], s43 offen lds
    v_mfma_f32_32x32x16_bf16 v[112:127], a[68:71], v[36:39], v[112:127]
    buffer_load_dwordx4 v14, s[8:11], s43 offen offset:1024 lds
    ds_read_b64_tr_b16 v[32:33], v18 offset:8192
    ds_read_b64_tr_b16 v[34:35], v18 offset:9216
    ds_read_b64_tr_b16 v[36:37], v19 offset:8192
    ds_read_b64_tr_b16 v[38:39], v19 offset:9216
    s_waitcnt vmcnt(26) lgkmcnt(4)
    v_mfma_f32_32x32x16_bf16 v[64:79], a[72:75], v[40:43], v[64:79]
    v_mfma_f32_32x32x16_bf16 v[80:95], a[72:75], v[44:47], v[80:95]
    v_mfma_f32_32x32x16_bf16 v[96:111], a[76:79], v[40:43], v[96:111]
    v_mfma_f32_32x32x16_bf16 v[112:127], a[76:79], v[44:47], v[112:127]
    ds_read_b64_tr_b16 v[40:41], v18 offset:10240
    ds_read_b64_tr_b16 v[42:43], v18 offset:11264
    ds_read_b64_tr_b16 v[44:45], v19 offset:10240
    ds_read_b64_tr_b16 v[46:47], v19 offset:11264
    s_waitcnt vmcnt(24) lgkmcnt(4)
    v_mfma_f32_32x32x16_bf16 v[64:79], a[0:3], v[32:35], v[64:79]
    v_mfma_f32_32x32x16_bf16 v[80:95], a[0:3], v[36:39], v[80:95]
    v_mfma_f32_32x32x16_bf16 v[96:111], a[4:7], v[32:35], v[96:111]
    s_add_u32 m0, s42, 22528
    s_add_u32 s43, s40, 1769472
    buffer_load_dwordx4 v13, s[8:11], s43 offen lds
    v_mfma_f32_32x32x16_bf16 v[112:127], a[4:7], v[36:39], v[112:127]
    buffer_load_dwordx4 v14, s[8:11], s43 offen offset:1024 lds
    s_waitcnt vmcnt(24)
    ds_read_b64_tr_b16 v[32:33], v18 offset:12288
    ds_read_b64_tr_b16 v[34:35], v18 offset:13312
    ds_read_b64_tr_b16 v[36:37], v19 offset:12288
    ds_read_b64_tr_b16 v[38:39], v19 offset:13312
    s_waitcnt vmcnt(22) lgkmcnt(4)
    v_mfma_f32_32x32x16_bf16 v[64:79], a[8:11], v[40:43], v[64:79]
    v_mfma_f32_32x32x16_bf16 v[80:95], a[8:11], v[44:47], v[80:95]
    v_mfma_f32_32x32x16_bf16 v[96:111], a[12:15], v[40:43], v[96:111]
    v_mfma_f32_32x32x16_bf16 v[112:127], a[12:15], v[44:47], v[112:127]
    s_waitcnt vmcnt(18)
    ds_read_b64_tr_b16 v[40:41], v18 offset:14336
    ds_read_b64_tr_b16 v[42:43], v18 offset:15360
    ds_read_b64_tr_b16 v[44:45], v19 offset:14336
    ds_read_b64_tr_b16 v[46:47], v19 offset:15360
    s_waitcnt lgkmcnt(4)
    v_mfma_f32_32x32x16_bf16 v[64:79], a[16:19], v[32:35], v[64:79]
    v_mfma_f32_32x32x16_bf16 v[80:95], a[16:19], v[36:39], v[80:95]
    v_mfma_f32_32x32x16_bf16 v[96:111], a[20:23], v[32:35], v[96:111]
    v_mfma_f32_32x32x16_bf16 v[112:127], a[20:23], v[36:39], v[112:127]
    s_waitcnt vmcnt(12)
    ds_read_b64_tr_b16 v[32:33], v18 offset:16384
    ds_read_b64_tr_b16 v[34:35], v18 offset:17408
    ds_read_b64_tr_b16 v[36:37], v19 offset:16384
    ds_read_b64_tr_b16 v[38:39], v19 offset:17408
    s_waitcnt lgkmcnt(4)
    v_mfma_f32_32x32x16_bf16 v[64:79], a[24:27], v[40:43], v[64:79]
    v_mfma_f32_32x32x16_bf16 v[80:95], a[24:27], v[44:47], v[80:95]
    v_mfma_f32_32x32x16_bf16 v[96:111], a[28:31], v[40:43], v[96:111]
    v_mfma_f32_32x32x16_bf16 v[112:127], a[28:31], v[44:47], v[112:127]
    s_waitcnt vmcnt(8)
    ds_read_b64_tr_b16 v[40:41], v18 offset:18432
    ds_read_b64_tr_b16 v[42:43], v18 offset:19456
    ds_read_b64_tr_b16 v[44:45], v19 offset:18432
    ds_read_b64_tr_b16 v[46:47], v19 offset:19456
    s_waitcnt lgkmcnt(4)
    v_mfma_f32_32x32x16_bf16 v[64:79], a[32:35], v[32:35], v[64:79]
    v_mfma_f32_32x32x16_bf16 v[80:95], a[32:35], v[36:39], v[80:95]
    v_mfma_f32_32x32x16_bf16 v[96:111], a[36:39], v[32:35], v[96:111]
    v_mfma_f32_32x32x16_bf16 v[112:127], a[36:39], v[36:39], v[112:127]
    s_waitcnt vmcnt(2)
    ds_read_b64_tr_b16 v[32:33], v18 offset:20480
    ds_read_b64_tr_b16 v[34:35], v18 offset:21504
    ds_read_b64_tr_b16 v[36:37], v19 offset:20480
    ds_read_b64_tr_b16 v[38:39], v19 offset:21504
    s_waitcnt lgkmcnt(4)
    v_mfma_f32_32x32x16_bf16 v[64:79], a[40:43], v[40:43], v[64:79]
    v_mfma_f32_32x32x16_bf16 v[80:95], a[40:43], v[44:47], v[80:95]
    v_mfma_f32_32x32x16_bf16 v[96:111], a[44:47], v[40:43], v[96:111]
    v_mfma_f32_32x32x16_bf16 v[112:127], a[44:47], v[44:47], v[112:127]
    s_waitcnt vmcnt(0)
    ds_read_b64_tr_b16 v[40:41], v18 offset:22528
    ds_read_b64_tr_b16 v[42:43], v18 offset:23552
    ds_read_b64_tr_b16 v[44:45], v19 offset:22528
    ds_read_b64_tr_b16 v[46:47], v19 offset:23552
    s_waitcnt lgkmcnt(4)
    v_mfma_f32_32x32x16_bf16 v[64:79], a[48:51], v[32:35], v[64:79]
    v_mfma_f32_32x32x16_bf16 v[80:95], a[48:51], v[36:39], v[80:95]
    v_mfma_f32_32x32x16_bf16 v[96:111], a[52:55], v[32:35], v[96:111]
    v_mfma_f32_32x32x16_bf16 v[112:127], a[52:55], v[36:39], v[112:127]
    s_waitcnt lgkmcnt(0)
    v_mfma_f32_32x32x16_bf16 v[64:79], a[56:59], v[40:43], v[64:79]
    v_mfma_f32_32x32x16_bf16 v[80:95], a[56:59], v[44:47], v[80:95]
    v_mfma_f32_32x32x16_bf16 v[96:111], a[60:63], v[40:43], v[96:111]
    v_mfma_f32_32x32x16_bf16 v[112:127], a[60:63], v[44:47], v[112:127]
    v_add_u32 v20, s42, v5
    s_xor_b32 s26, s3, 1
    s_lshl_b32 s26, s26, 15
    v_add_u32 v21, s26, v5
    s_xor_b32 s26, s3, 2
    s_lshl_b32 s26, s26, 15
    v_add_u32 v22, s26, v5
    s_xor_b32 s26, s3, 3
    s_lshl_b32 s26, s26, 15
    v_add_u32 v23, s26, v5
    ds_write_b128 v20, v[80:83] offset:16384
    ds_write_b128 v20, v[84:87] offset:17408
    ds_write_b128 v20, v[88:91] offset:18432
    ds_write_b128 v20, v[92:95] offset:19456
    ds_write_b128 v20, v[96:99] offset:20480
    ds_write_b128 v20, v[100:103] offset:21504
    ds_write_b128 v20, v[104:107] offset:22528
    ds_write_b128 v20, v[108:111] offset:23552
    ds_write_b128 v20, v[112:115] offset:24576
    ds_write_b128 v20, v[116:119] offset:25600
    ds_write_b128 v20, v[120:123] offset:26624
    ds_write_b128 v20, v[124:127] offset:27648
    s_lshl_b32 s26, s3, 12
    s_add_u32 s26, s26, 131072
    v_add_u32 v4, s26, v5
    v_lshlrev_b32 v24, 16, v24
    v_pk_add_f32 v[64:65], v[64:65], v[24:25] op_sel_hi:[1,0]
    v_pk_add_f32 v[66:67], v[66:67], v[24:25] op_sel_hi:[1,0]
    v_pk_add_f32 v[68:69], v[68:69], v[24:25] op_sel_hi:[1,0]
    v_pk_add_f32 v[70:71], v[70:71], v[24:25] op_sel_hi:[1,0]
    v_pk_add_f32 v[72:73], v[72:73], v[24:25] op_sel_hi:[1,0]
    v_pk_add_f32 v[74:75], v[74:75], v[24:25] op_sel_hi:[1,0]
    v_pk_add_f32 v[76:77], v[76:77], v[24:25] op_sel_hi:[1,0]
    v_pk_add_f32 v[78:79], v[78:79], v[24:25] op_sel_hi:[1,0]
    s_waitcnt lgkmcnt(0)
    s_mov_b64 exec, 1
    ds_add_u32 v8, v9 offset:36
    s_mov_b64 exec, -1
    s_mov_b32 s44, 524288
sp_75:
    ds_read_b32 v10, v8 offset:32
    s_waitcnt lgkmcnt(0)
    v_readfirstlane_b32 s45, v10
    s_sub_u32 s44, s44, 1
    s_cbranch_scc1 spe_76
    s_cmp_ge_u32 s45, 4
    s_cbranch_scc1 spe_76
    s_sleep 0
    s_branch sp_75
spe_76:
    ds_read_b128 v[32:35], v4 offset:0
    ds_read_b128 v[36:39], v4 offset:1024
    ds_read_b128 v[40:43], v4 offset:2048
    ds_read_b128 v[44:47], v4 offset:3072
    s_mov_b32 s44, 524288
sp_77:
    ds_read_b32 v10, v8 offset:36
    s_waitcnt lgkmcnt(0)
    v_readfirstlane_b32 s45, v10
    s_sub_u32 s44, s44, 1
    s_cbranch_scc1 spe_78
    s_cmp_ge_u32 s45, 4
    s_cbranch_scc1 spe_78
    s_sleep 0
    s_branch sp_77
spe_78:
    ds_read_b128 v[80:83], v21 offset:16384
    ds_read_b128 v[84:87], v21 offset:17408
    ds_read_b128 v[88:91], v21 offset:18432
    ds_read_b128 v[92:95], v21 offset:19456
    ds_read_b128 v[96:99], v22 offset:20480
    ds_read_b128 v[100:103], v22 offset:21504
    ds_read_b128 v[104:107], v22 offset:22528
    ds_read_b128 v[108:111], v22 offset:23552
    ds_read_b128 v[112:115], v23 offset:24576
    ds_read_b128 v[116:119], v23 offset:25600
    ds_read_b128 v[120:123], v23 offset:26624
    ds_read_b128 v[124:127], v23 offset:27648
    s_waitcnt lgkmcnt(8)
    v_pk_add_f32 v[64:65], v[64:65], v[80:81]
    v_pk_add_f32 v[66:67], v[66:67], v[82:83]
    v_pk_add_f32 v[68:69], v[68:69], v[84:85]
    v_pk_add_f32 v[70:71], v[70:71], v[86:87]
    v_pk_add_f32 v[72:73], v[72:73], v[88:89]
    v_pk_add_f32 v[74:75], v[74:75], v[90:91]
    v_pk_add_f32 v[76:77], v[76:77], v[92:93]
    v_pk_add_f32 v[78:79], v[78:79], v[94:95]
    s_waitcnt lgkmcnt(4)
    v_pk_add_f32 v[64:65], v[64:65], v[96:97]
    v_pk_add_f32 v[66:67], v[66:67], v[98:99]
    v_pk_add_f32 v[68:69], v[68:69], v[100:101]
    v_pk_add_f32 v[70:71], v[70:71], v[102:103]
    v_pk_add_f32 v[72:73], v[72:73], v[104:105]
    v_pk_add_f32 v[74:75], v[74:75], v[106:107]
    v_pk_add_f32 v[76:77], v[76:77], v[108:109]
    v_pk_add_f32 v[78:79], v[78:79], v[110:111]
    s_waitcnt lgkmcnt(0)
    v_pk_add_f32 v[64:65], v[64:65], v[112:113]
    v_pk_add_f32 v[66:67], v[66:67], v[114:115]
    v_pk_add_f32 v[68:69], v[68:69], v[116:117]
    v_pk_add_f32 v[70:71], v[70:71], v[118:119]
    v_pk_add_f32 v[72:73], v[72:73], v[120:121]
    v_pk_add_f32 v[74:75], v[74:75], v[122:123]
    v_pk_add_f32 v[76:77], v[76:77], v[124:125]
    v_pk_add_f32 v[78:79], v[78:79], v[126:127]
    v_pk_fma_f32 v[64:65], v[64:65], v[26:27], v[32:33] op_sel_hi:[1,0,1]
    v_pk_fma_f32 v[66:67], v[66:67], v[26:27], v[34:35] op_sel_hi:[1,0,1]
    v_pk_fma_f32 v[68:69], v[68:69], v[26:27], v[36:37] op_sel_hi:[1,0,1]
    v_pk_fma_f32 v[70:71], v[70:71], v[26:27], v[38:39] op_sel_hi:[1,0,1]
    v_pk_fma_f32 v[72:73], v[72:73], v[26:27], v[40:41] op_sel_hi:[1,0,1]
    v_pk_fma_f32 v[74:75], v[74:75], v[26:27], v[42:43] op_sel_hi:[1,0,1]
    v_pk_fma_f32 v[76:77], v[76:77], v[26:27], v[44:45] op_sel_hi:[1,0,1]
    v_pk_fma_f32 v[78:79], v[78:79], v[26:27], v[46:47] op_sel_hi:[1,0,1]
    v_cvt_pk_bf16_f32 v48, v64, v65
    v_cvt_pk_bf16_f32 v49, v66, v67
    v_cvt_pk_bf16_f32 v50, v68, v69
    v_cvt_pk_bf16_f32 v51, v70, v71
    v_cvt_pk_bf16_f32 v52, v72, v73
    v_cvt_pk_bf16_f32 v53, v74, v75
    v_cvt_pk_bf16_f32 v54, v76, v77
    v_cvt_pk_bf16_f32 v55, v78, v79
    v_permlane32_swap_b32 v48, v50
    v_permlane32_swap_b32 v49, v51
    buffer_store_dwordx4 v[48:51], v3, s[28:31], s38 offen offset:0
    v_permlane32_swap_b32 v52, v54
    v_permlane32_swap_b32 v53, v55
    buffer_store_dwordx4 v[52:55], v3, s[28:31], s38 offen offset:32
    s_endpgm
k_end:
    s_endpgm
.section .rodata,"a"
.p2align 6
.amdhsa_kernel gated_mix__spectral_gfnet__mixer_token_mlp__prompt_kernel
  .amdhsa_next_free_vgpr 256
  .amdhsa_next_free_sgpr 96
  .amdhsa_accum_offset 128
  .amdhsa_group_segment_fixed_size 0
  .amdhsa_kernarg_size 96
  .amdhsa_user_sgpr_count 2
  .amdhsa_user_sgpr_kernarg_segment_ptr 1
  .amdhsa_system_sgpr_workgroup_id_x 1
  .amdhsa_float_denorm_mode_32 3
.end_amdhsa_kernel
```
